```python
import torch

def _softmax(x, axis=-1):
    return torch.softmax(x, dim=axis)
def _gelu(x):
    return torch.nn.functional.gelu(x, approximate="tanh")
def _silu(x):
    return torch.nn.functional.silu(x)
def _sigmoid(x):
    return torch.sigmoid(x)
def _layernorm(x, axis=-1, eps=1e-5):
    m = x.mean(dim=axis, keepdim=True)
    v = x.var(dim=axis, keepdim=True, unbiased=False)
    return (x - m) / torch.sqrt(v + eps)
def _scatter_add(tgt, idx, src, axis=0):
    return tgt.clone().index_add_(axis, idx, src)
def _segment_sum(src, seg, n):
    out = torch.zeros((n,) + src.shape[1:], dtype=src.dtype)
    return out.index_add_(0, seg, src)
def _pad(x, pw):
    flat = tuple(v for pair in reversed(pw) for v in pair)
    return torch.nn.functional.pad(x, flat)

kernel_name = 'gated_mix__softmax_full_mha__glu_gated_geglu__prompt'

def setup_inputs():

    _w = (lambda a: (lambda t: t.to(torch.bfloat16) if t.is_floating_point() else t)(torch.as_tensor(a)))
    def _A_setup():
        B, S, D = 1, 2048, 640
        return {
            "x": _w((lambda *s: torch.randn(*s, dtype=torch.bfloat16) * 0.05)(B, S, D)),
            "wqkv": _w((lambda *s: torch.randn(*s, dtype=torch.bfloat16) * 0.8)(D, 3 * D)),
            "wo": _w((lambda *s: torch.randn(*s, dtype=torch.bfloat16) * 0.05)(D, D)),
        }
    _A_in = _A_setup()

    def _B_setup():
        B, S, Dm, Df = 1, 2048, 640, 1536
        return {
            "x": _w((lambda *s: torch.randn(*s, dtype=torch.bfloat16) * 0.05)(B, S, Dm)),
            "w_gate": _w((lambda *s: torch.randn(*s, dtype=torch.bfloat16) * 3.2)(Dm, Df) * (Dm ** -0.5)),
            "w_up": _w((lambda *s: torch.randn(*s, dtype=torch.bfloat16) * 3.2)(Dm, Df) * (Dm ** -0.5)),
            "w_down": _w((lambda *s: torch.randn(*s, dtype=torch.bfloat16) * 3.2)(Df, Dm) * (Df ** -0.5)),
        }
    _B_in = _B_setup()

    return {
        "A_x": _A_in["x"],
        "A_wqkv": _A_in["wqkv"],
        "A_wo": _A_in["wo"],
        "B_x": _B_in["x"],
        "B_w_gate": _B_in["w_gate"],
        "B_w_up": _B_in["w_up"],
        "B_w_down": _B_in["w_down"],
        "gate_w": _w((lambda *s: torch.randn(*s, dtype=torch.bfloat16) * 0.05)(640) * 16.0),
    }

def reference(A_x, A_wqkv, A_wo, B_x, B_w_gate, B_w_up, B_w_down, gate_w):
    def _A_ref(x, wqkv, wo):
        B, S, D = x.shape
        H = 32; Dh = D // H
        qkv = (lambda x, *d: x.permute(*d))((x @ wqkv).reshape(B, S, 3, H, Dh), 2, 0, 3, 1, 4)
        q, k, v = qkv[0], qkv[1], qkv[2]
        scale = Dh ** -0.5
        scores = torch.einsum("bhqd,bhkd->bhqk", q, k) * scale
        p = _softmax(scores, axis=-1)
        o = torch.einsum("bhqk,bhkd->bhqd", p, v)
        return (lambda x, *d: x.permute(*d))(o, 0, 2, 1, 3).reshape(B, S, D) @ wo

    def _B_ref(x, w_gate, w_up, w_down):
        g = torch.einsum("bsd,df->bsf", x, w_gate)
        u = torch.einsum("bsd,df->bsf", x, w_up)
        h = _gelu(g) * u
        return torch.einsum("bsf,fd->bsd", h, w_down)

    x = A_x
    g = _sigmoid((x * gate_w).sum(-1, keepdims=True))
    a = _A_ref(x, A_wqkv, A_wo)
    b = _B_ref(x, B_w_gate, B_w_up, B_w_down)
    return g * a + (1 - g) * b
```

```asm
; @launch grid=(256,1,1) block=(256,1,1) lds=151616
.amdgcn_target "amdgcn-amd-amdhsa--gfx950"
.text
.globl gated_mix__softmax_full_mha__glu_gated_geglu__prompt_kernel
.p2align 8
.type gated_mix__softmax_full_mha__glu_gated_geglu__prompt_kernel,@function
gated_mix__softmax_full_mha__glu_gated_geglu__prompt_kernel:
    s_cmp_ge_u32 s2, 256
    s_cbranch_scc1 MK_END
    s_load_dwordx4 s[4:7], s[0:1], 0
    s_load_dwordx2 s[8:9], s[0:1], 16
    s_load_dwordx8 s[12:19], s[0:1], 32
    s_load_dwordx2 s[10:11], s[0:1], 80
    s_load_dwordx2 s[30:31], s[0:1], 72
    v_lshrrev_b32 v1, 6, v0
    s_and_b32 s39, s2, 7
    v_readfirstlane_b32 s36, v1
    v_and_b32 v1, 63, v0
    s_lshr_b32 s40, s2, 3
    v_lshrrev_b32 v2, 5, v1
    s_cmp_ge_u32 s40, 24
    s_cbranch_scc1 P1_AUX
    s_lshr_b32 s37, s39, 2
    s_lshl_b32 s37, s37, 3
    s_and_b32 s41, s40, 7
    s_add_u32 s37, s37, s41
    s_and_b32 s38, s39, 3
    s_lshr_b32 s42, s40, 3
    s_lshl_b32 s43, s42, 2
    s_add_u32 s38, s38, s43
    s_mul_i32 s55, s41, 5
    s_mul_i32 s56, s42, 0
    s_add_u32 s55, s55, s56
    s_lshr_b32 s55, s55, 2
    s_cmp_ge_u32 s55, 10
    s_cselect_b32 s56, 10, 0
    s_sub_u32 s47, s55, s56
    v_lshrrev_b32 v4, 3, v1
    s_lshl_b32 s41, s36, 5
    v_add_u32 v4, s41, v4
    v_mul_u32_u24 v4, 1280, v4
    v_and_b32 v5, 7, v1
    v_lshrrev_b32 v6, 4, v1
    v_xor_b32 v5, v5, v6
    v_lshl_add_u32 v20, v5, 4, v4
    v_xor_b32 v4, 64, v20
    v_add_u32 v21, 9216, v4
    v_add_u32 v22, 18432, v20
    v_add_u32 v23, 27648, v4
    s_mul_i32 s41, s37, 163840
    s_lshl_b32 s55, s47, 7
    s_add_u32 s41, s41, s55
    s_lshl_b32 s48, s36, 12
    s_mul_i32 s49, s36, 5120
    s_add_u32 s49, s49, 16384
    s_add_u32 s63, s49, 4096
    s_mul_i32 s42, s38, 320
    s_mul_i32 s55, s47, 245760
    s_add_u32 s42, s42, s55
    s_mov_b32 s43, 0
    s_mov_b32 s66, 0xfffffb80
    s_movk_i32 s67, 128
    s_mov_b32 s68, 0xffde4000
    s_mov_b32 s69, 245760
    s_mov_b32 s70, 0xfffee000
    s_mov_b32 s71, 36864
    v_mul_u32_u24 v5, 3277, v1
    v_lshrrev_b32 v5, 16, v5
    v_mul_u32_u24 v6, 20, v5
    v_sub_u32 v6, v1, v6
    v_mul_u32_u24 v5, 3840, v5
    v_lshl_add_u32 v5, v6, 4, v5
    s_mul_i32 s53, s36, 61440
    v_add_u32 v24, s53, v5
    v_cmp_lt_u32 vcc, 15, v6
    v_mov_b32 v4, 10560
    v_mov_b32 v5, 14080
    v_cndmask_b32 v4, v4, v5, vcc
    v_add_u32 v25, v24, v4
    v_cmp_lt_u32 vcc, 11, v6
    v_mov_b32 v4, 21120
    v_mov_b32 v5, 24640
    v_cndmask_b32 v4, v4, v5, vcc
    v_add_u32 v26, v24, v4
    v_cmp_lt_u32 vcc, 7, v6
    v_mov_b32 v4, 31680
    v_mov_b32 v5, 35200
    v_cndmask_b32 v4, v4, v5, vcc
    v_add_u32 v27, v24, v4
    v_cmp_lt_u32 vcc, 3, v6
    v_mov_b32 v4, 46336
    v_mov_b32 v5, 49856
    v_cndmask_b32 v4, v4, v5, vcc
    v_add_u32 v28, v24, v4
    s_waitcnt lgkmcnt(0)
    s_mov_b32 s32, s30
    s_mov_b32 s33, s31
    s_add_u32 s20, s4, s41
    s_addc_u32 s21, s5, 0
    s_mov_b32 s22, 2621440
    s_mov_b32 s23, 0x00020000
    s_add_u32 s24, s6, s42
    s_addc_u32 s25, s7, 0
    s_mov_b32 s26, 2457600
    s_mov_b32 s27, 0x00020000
    s_add_u32 m0, s43, s48
    s_nop 0
    buffer_load_dwordx4 v20, s[20:23], 0 offen offset:0 lds
    buffer_load_dwordx4 v21, s[20:23], 0 offen offset:1024 lds
    buffer_load_dwordx4 v22, s[20:23], 0 offen offset:2048 lds
    buffer_load_dwordx4 v23, s[20:23], 0 offen offset:3072 lds
    s_add_u32 m0, s43, s49
    s_nop 0
    buffer_load_dwordx4 v24, s[24:27], 0 offen offset:0 lds
    buffer_load_dwordx4 v25, s[24:27], 0 offen offset:1024 lds
    buffer_load_dwordx4 v26, s[24:27], 0 offen offset:2048 lds
    buffer_load_dwordx4 v27, s[24:27], 0 offen offset:3072 lds
    s_add_u32 m0, s43, s63
    s_nop 0
    buffer_load_dwordx4 v28, s[24:27], 0 offen offset:0 lds
    s_add_u32 s47, s47, 1
    s_cmp_eq_u32 s47, 10
    s_cselect_b32 s47, 0, s47
    s_cselect_b32 s64, s66, s67
    s_cselect_b32 s65, s68, s69
    s_cselect_b32 s62, -1, 0
    s_add_u32 s20, s20, s64
    s_addc_u32 s21, s21, s62
    s_add_u32 s24, s24, s65
    s_addc_u32 s25, s25, s62
    s_mov_b32 s43, 36864
    s_and_b32 s46, s36, 1
    s_lshr_b32 s58, s36, 1
    s_lshl_b32 s40, s46, 1
    s_add_u32 s40, s40, s58
    s_xor_b32 s41, s40, 1
    v_and_b32 v9, 31, v1
    v_lshrrev_b32 v10, 1, v9
    v_and_b32 v10, 7, v10
    v_xor_b32 v10, v10, v2
    s_lshl_b32 s42, s40, 12
    s_lshl_b32 s53, s41, 12
    v_lshlrev_b32 v11, 7, v9
    v_xor_b32 v12, 0, v10
    v_lshl_add_u32 v12, v12, 4, v11
    v_add_u32 v4, s42, v12
    v_add_u32 v16, s53, v12
    v_xor_b32 v12, 2, v10
    v_lshl_add_u32 v12, v12, 4, v11
    v_add_u32 v5, s42, v12
    v_add_u32 v17, s53, v12
    v_xor_b32 v12, 4, v10
    v_lshl_add_u32 v12, v12, 4, v11
    v_add_u32 v6, s42, v12
    v_add_u32 v18, s53, v12
    v_xor_b32 v12, 6, v10
    v_lshl_add_u32 v12, v12, 4, v11
    v_add_u32 v7, s42, v12
    v_add_u32 v19, s53, v12
    s_add_u32 m0, s43, s48
    s_nop 0
    buffer_load_dwordx4 v20, s[20:23], 0 offen offset:0 lds
    buffer_load_dwordx4 v21, s[20:23], 0 offen offset:1024 lds
    buffer_load_dwordx4 v22, s[20:23], 0 offen offset:2048 lds
    buffer_load_dwordx4 v23, s[20:23], 0 offen offset:3072 lds
    v_lshrrev_b32 v12, 2, v1
    v_and_b32 v12, 3, v12
    v_lshl_add_u32 v12, v2, 3, v12
    v_and_b32 v13, 3, v1
    v_lshrrev_b32 v14, 4, v1
    v_and_b32 v14, 1, v14
    s_mov_b32 s45, 0
    v_mul_u32_u24 v12, 320, v12
    v_mul_u32_u24 v15, 160, v14
    v_add_u32 v12, v15, v12
    v_add_u32 v12, 16384, v12
    v_mul_u32_u24 v10, 40, v13
    v_add_u32 v10, 32, v10
    v_add_u32 v3, v12, v10
    s_mul_i32 s42, s58, 80
    v_add_u32 v12, s42, v12
    v_pk_mov_b32 v[32:33], 0, 0
    v_pk_mov_b32 v[34:35], 0, 0
    s_nop 1
    v_mfma_f32_32x32x16_bf16 v[48:63], v[32:35], v[32:35], 0
    v_mfma_f32_32x32x16_bf16 v[64:79], v[32:35], v[32:35], 0
    v_mfma_f32_32x32x16_bf16 v[80:95], v[32:35], v[32:35], 0
    v_mfma_f32_32x32x16_bf16 v[96:111], v[32:35], v[32:35], 0
    v_mfma_f32_32x32x16_bf16 v[112:127], v[32:35], v[32:35], 0
    v_mfma_f32_32x32x16_bf16 a[0:15], v[32:35], v[32:35], 0
    v_mfma_f32_32x32x16_bf16 a[16:31], v[32:35], v[32:35], 0
    v_mfma_f32_32x32x16_bf16 a[32:47], v[32:35], v[32:35], 0
    v_mfma_f32_32x32x16_bf16 a[48:63], v[32:35], v[32:35], 0
    s_mov_b32 s28, s10
    s_mov_b32 s29, s11
    s_mov_b32 s30, 0x2000000
    s_mov_b32 s31, 0x00020000
    v_and_b32 v130, 31, v1
    v_mul_u32_u24 v249, 0x7f0000, v2
    v_lshlrev_b32 v249, 8, v249
    v_lshl_add_u32 v249, v130, 2, v249
    v_lshrrev_b32 v29, 1, v130
    v_and_b32 v29, 7, v29
    v_xor_b32 v29, v29, v2
    s_and_b32 s3, s36, 1
    s_lshl_b32 s3, s3, 13
    s_add_u32 s3, s3, 110592
    v_lshlrev_b32 v30, 7, v130
    v_add_u32 v30, s3, v30
    v_xor_b32 v31, 0, v29
    v_lshl_add_u32 v142, v31, 4, v30
    v_xor_b32 v31, 2, v29
    v_lshl_add_u32 v143, v31, 4, v30
    v_xor_b32 v31, 4, v29
    v_lshl_add_u32 v144, v31, 4, v30
    v_xor_b32 v31, 6, v29
    v_lshl_add_u32 v145, v31, 4, v30
    v_lshrrev_b32 v31, 2, v1
    v_and_b32 v31, 3, v31
    v_lshl_add_u32 v31, v2, 3, v31
    v_mul_u32_u24 v31, 192, v31
    v_lshrrev_b32 v29, 4, v1
    v_and_b32 v29, 1, v29
    v_mul_u32_u24 v29, 12320, v29
    v_add_u32 v31, v31, v29
    v_and_b32 v29, 1, v1
    v_lshl_add_u32 v31, v29, 4, v31
    v_and_b32 v29, 2, v1
    v_lshl_add_u32 v31, v29, 2, v31
    s_lshr_b32 s3, s36, 1
    s_mul_i32 s3, s3, 96
    s_add_u32 s3, s3, 126976
    v_add_u32 v146, s3, v31
    s_and_b32 s3, s2, 1
    s_lshl_b32 s3, s3, 2
    s_lshr_b32 s34, s2, 6
    s_add_u32 s3, s3, s34
    s_mul_i32 s3, s3, 5
    s_lshr_b32 s34, s3, 1
    s_mul_i32 s34, s34, 139264
    s_and_b32 s3, s3, 1
    s_lshl_b32 s35, s3, 8
    s_add_u32 s34, s34, s35
    s_mul_i32 s35, s36, 24576
    s_add_u32 s34, s34, s35
    s_add_u32 s34, s34, 0x1180000
    s_mul_i32 s3, s3, 138752
    s_add_u32 s3, s3, 256
    v_and_b32 v29, 15, v1
    v_lshlrev_b32 v29, 4, v29
    v_lshrrev_b32 v30, 4, v1
    v_lshl_add_u32 v29, v30, 9, v29
    v_add_u32 v244, s34, v29
    v_add_u32 v245, s3, v244
    v_add_u32 v246, 139264, v244
    v_add_u32 v247, 139264, v245
    v_add_u32 v248, 278528, v244
    v_lshrrev_b32 v29, 3, v1
    s_lshl_b32 s3, s36, 5
    v_add_u32 v29, s3, v29
    v_mul_u32_u24 v29, 1280, v29
    v_and_b32 v30, 7, v1
    v_lshrrev_b32 v31, 4, v1
    v_xor_b32 v30, v30, v31
    v_lshl_add_u32 v132, v30, 4, v29
    v_xor_b32 v29, 64, v132
    v_add_u32 v133, 9216, v29
    v_add_u32 v134, 18432, v132
    v_add_u32 v135, 27648, v29
    s_and_b32 s3, s36, 1
    s_mul_i32 s3, s3, 384
    v_add_u32 v29, s3, v1
    v_mul_u32_u24 v30, 5462, v29
    v_lshrrev_b32 v30, 16, v30
    v_mul_u32_u24 v31, 12, v30
    v_sub_u32 v31, v29, v31
    v_mul_u32_u24 v30, 3072, v30
    v_lshl_add_u32 v136, v31, 4, v30
    v_cmp_lt_u32 vcc, 7, v31
    v_mov_b32 v29, 14400
    v_mov_b32 v30, 17280
    v_cndmask_b32 v29, v29, v30, vcc
    v_add_u32 v137, v136, v29
    v_cmp_lt_u32 vcc, 3, v31
    v_mov_b32 v29, 28800
    v_mov_b32 v30, 31680
    v_cndmask_b32 v29, v29, v30, vcc
    v_add_u32 v138, v136, v29
    v_add_u32 v139, 46080, v136
    v_add_u32 v140, 50176, v137
    v_add_u32 v141, 50176, v138
    s_lshr_b32 s72, s2, 3
    s_and_b32 s73, s72, 7
    s_lshr_b32 s74, s72, 3
    s_mul_i32 s75, s73, 5
    s_mul_i32 s76, s74, 10
    s_add_u32 s75, s75, s76
    s_lshr_b32 s75, s75, 2
    s_cmp_ge_u32 s75, 10
    s_cselect_b32 s76, 10, 0
    s_sub_u32 s75, s75, s76
    s_and_b32 s76, s2, 4
    s_lshl_b32 s76, s76, 1
    s_add_u32 s73, s73, s76
    s_mul_i32 s73, s73, 163840
    s_lshl_b32 s76, s75, 7
    s_add_u32 s3, s73, s76
    s_and_b32 s76, s2, 3
    s_lshl_b32 s76, s76, 2
    s_add_u32 s74, s74, s76
    s_mul_i32 s74, s74, 192
    s_mul_i32 s78, s75, 196608
    s_add_u32 s78, s74, s78
    s_mov_b32 s74, s3
    s_mov_b32 s3, s75
    s_cmp_lt_u32 s36, 2
    s_cselect_b32 s76, s12, s14
    s_cselect_b32 s77, s13, s15
    s_add_u32 s76, s76, s78
    s_addc_u32 s77, s77, 0
    s_mov_b32 s78, 1966080
    s_mov_b32 s79, 0x00020000
    s_add_u32 s72, s4, s74
    s_addc_u32 s73, s5, 0
    s_mov_b32 s74, 2621440
    s_mov_b32 s75, 0x00020000
    s_mov_b32 s46, s41
    s_lshl_b32 s59, s37, 2
    s_and_b32 s55, s38, 3
    s_mul_i32 s55, s55, 655360
    s_add_u32 s56, s59, s46
    s_add_u32 s59, s59, s40
    s_mul_i32 s59, s59, 1280
    s_mul_i32 s56, s56, 1280
    s_add_u32 s56, s56, s55
    s_add_u32 s55, s55, s59
    s_mov_b32 s57, 81920
    s_mul_i32 s58, s58, 163840
    s_cmp_ge_u32 s38, 8
    s_cbranch_scc1 P1_V
    v_and_b32 v14, 1, v13
    v_lshl_add_u32 v12, v14, 4, v12
    v_lshrrev_b32 v14, 1, v13
    v_lshl_add_u32 v8, v14, 3, v12
    s_cmp_lt_u32 s38, 4
    s_cselect_b32 s50, 0x3ea52b5c, 1.0
    s_mov_b32 s51, s50
    s_cselect_b32 s52, 0x0, 0x280000
    s_add_u32 s55, s55, s52
    s_add_u32 s56, s56, s52
    v_lshlrev_b32 v10, 4, v1
    v_lshlrev_b32 v11, 3, v9
    v_mad_u32_u24 v11, v2, s57, v11
    s_add_u32 s60, s55, s58
    s_add_u32 s61, s56, s58
    s_waitcnt vmcnt(4)
    s_barrier
    ds_read_b128 a[64:67], v4
    ds_read_b64_tr_b16 a[80:81], v8 offset:0
    ds_read_b64_tr_b16 a[82:83], v8 offset:1280
    ds_read_b128 a[68:71], v16
    ds_read_b64_tr_b16 a[84:85], v8 offset:40
    ds_read_b64_tr_b16 a[86:87], v8 offset:1320
    ds_read_b64_tr_b16 a[88:89], v3 offset:0
    ds_read_b64_tr_b16 a[90:91], v3 offset:1280
    s_add_u32 m0, s43, s49
    s_nop 0
    buffer_load_dwordx4 v24, s[24:27], 0 offen offset:0 lds
    buffer_load_dwordx4 v25, s[24:27], 0 offen offset:1024 lds
    buffer_load_dwordx4 v26, s[24:27], 0 offen offset:2048 lds
    buffer_load_dwordx4 v27, s[24:27], 0 offen offset:3072 lds
    s_add_u32 m0, s43, s63
    s_nop 0
    buffer_load_dwordx4 v28, s[24:27], 0 offen offset:0 lds
    s_add_u32 s47, s47, 1
    s_cmp_eq_u32 s47, 10
    s_cselect_b32 s47, 0, s47
    s_cselect_b32 s64, s66, s67
    s_cselect_b32 s65, s68, s69
    s_cselect_b32 s62, -1, 0
    s_add_u32 s20, s20, s64
    s_addc_u32 s21, s21, s62
    s_add_u32 s24, s24, s65
    s_addc_u32 s25, s25, s62
    s_mov_b32 s43, 73728
    s_add_u32 m0, s43, s48
    s_mov_b32 s44, 0
    buffer_load_dwordx4 v20, s[20:23], 0 offen offset:0 lds
    buffer_load_dwordx4 v21, s[20:23], 0 offen offset:1024 lds
.p2align 6
P1_QK_LOOP:
    s_waitcnt lgkmcnt(5)
    v_mfma_f32_32x32x16_bf16 v[48:63], a[80:83], a[64:67], v[48:63]
    s_waitcnt lgkmcnt(4)
    ds_read_b128 a[72:75], v5
    ds_read_b64_tr_b16 a[92:93], v8 offset:5120
    v_mfma_f32_32x32x16_bf16 v[80:95], a[80:83], a[68:71], v[80:95]
    s_waitcnt lgkmcnt(4)
    ds_read_b64_tr_b16 a[94:95], v8 offset:6400
    ds_read_b128 a[76:79], v17
    v_mfma_f32_32x32x16_bf16 v[64:79], a[84:87], a[64:67], v[64:79]
    ds_read_b64_tr_b16 a[96:97], v8 offset:5160
    ds_read_b64_tr_b16 a[98:99], v8 offset:6440
    buffer_load_dwordx4 v22, s[20:23], 0 offen offset:2048 lds
    v_mfma_f32_32x32x16_bf16 v[96:111], a[84:87], a[68:71], v[96:111]
    s_waitcnt lgkmcnt(6)
    ds_read_b64_tr_b16 a[100:101], v3 offset:5120
    ds_read_b64_tr_b16 a[102:103], v3 offset:6400
    buffer_load_dwordx4 v23, s[20:23], 0 offen offset:3072 lds
    s_add_u32 m0, s43, s49
    v_mfma_f32_32x32x16_bf16 v[112:127], a[88:91], a[64:67], v[112:127]
    buffer_load_dwordx4 v24, s[24:27], 0 offen offset:0 lds
    s_waitcnt lgkmcnt(5)
    v_mfma_f32_32x32x16_bf16 v[48:63], a[92:95], a[72:75], v[48:63]
    s_waitcnt lgkmcnt(4)
    ds_read_b128 a[64:67], v6
    ds_read_b64_tr_b16 a[80:81], v8 offset:10240
    v_mfma_f32_32x32x16_bf16 v[80:95], a[92:95], a[76:79], v[80:95]
    s_waitcnt lgkmcnt(4)
    ds_read_b64_tr_b16 a[82:83], v8 offset:11520
    ds_read_b128 a[68:71], v18
    v_mfma_f32_32x32x16_bf16 v[64:79], a[96:99], a[72:75], v[64:79]
    ds_read_b64_tr_b16 a[84:85], v8 offset:10280
    ds_read_b64_tr_b16 a[86:87], v8 offset:11560
    buffer_load_dwordx4 v25, s[24:27], 0 offen offset:1024 lds
    v_mfma_f32_32x32x16_bf16 v[96:111], a[96:99], a[76:79], v[96:111]
    s_waitcnt lgkmcnt(6)
    ds_read_b64_tr_b16 a[88:89], v3 offset:10240
    ds_read_b64_tr_b16 a[90:91], v3 offset:11520
    buffer_load_dwordx4 v26, s[24:27], 0 offen offset:2048 lds
    v_mfma_f32_32x32x16_bf16 v[112:127], a[100:103], a[72:75], v[112:127]
    buffer_load_dwordx4 v27, s[24:27], 0 offen offset:3072 lds
    s_waitcnt lgkmcnt(5)
    v_mfma_f32_32x32x16_bf16 v[48:63], a[80:83], a[64:67], v[48:63]
    s_waitcnt lgkmcnt(4)
    ds_read_b128 a[72:75], v7
    ds_read_b64_tr_b16 a[92:93], v8 offset:15360
    v_mfma_f32_32x32x16_bf16 v[80:95], a[80:83], a[68:71], v[80:95]
    s_waitcnt lgkmcnt(4)
    ds_read_b64_tr_b16 a[94:95], v8 offset:16640
    ds_read_b128 a[76:79], v19
    s_add_u32 m0, s43, s63
    v_mfma_f32_32x32x16_bf16 v[64:79], a[84:87], a[64:67], v[64:79]
    ds_read_b64_tr_b16 a[96:97], v8 offset:15400
    ds_read_b64_tr_b16 a[98:99], v8 offset:16680
    buffer_load_dwordx4 v28, s[24:27], 0 offen offset:0 lds
    v_mfma_f32_32x32x16_bf16 v[96:111], a[84:87], a[68:71], v[96:111]
    s_waitcnt lgkmcnt(6)
    ds_read_b64_tr_b16 a[100:101], v3 offset:15360
    ds_read_b64_tr_b16 a[102:103], v3 offset:16640
    v_mfma_f32_32x32x16_bf16 v[112:127], a[88:91], a[64:67], v[112:127]
    s_add_u32 s47, s47, 1
    s_cmp_eq_u32 s47, 10
    s_cselect_b32 s47, 0, s47
    s_cselect_b32 s64, s66, s67
    s_cselect_b32 s65, s68, s69
    s_cselect_b32 s62, -1, 0
    s_add_u32 s20, s20, s64
    s_addc_u32 s21, s21, s62
    s_add_u32 s24, s24, s65
    s_addc_u32 s25, s25, s62
    s_cmp_ge_u32 s44, 7
    s_cselect_b32 s22, 0, s22
    s_cselect_b32 s26, 0, s26
    s_waitcnt lgkmcnt(0)
    v_mfma_f32_32x32x16_bf16 v[48:63], a[92:95], a[72:75], v[48:63]
    s_mov_b32 s43, s45
    s_add_u32 s45, s45, 36864
    s_cmp_eq_u32 s45, 110592
    s_cselect_b32 s45, 0, s45
    s_cselect_b32 s46, s70, s71
    v_add_u32 v4, s46, v4
    v_add_u32 v8, s46, v8
    v_add_u32 v16, s46, v16
    v_add_u32 v3, s46, v3
    s_waitcnt vmcnt(9)
    s_barrier
P1_QK_LOOP_NB:
    v_mfma_f32_32x32x16_bf16 v[80:95], a[92:95], a[76:79], v[80:95]
    ds_read_b128 a[64:67], v4
    ds_read_b64_tr_b16 a[80:81], v8 offset:0
    ds_read_b64_tr_b16 a[82:83], v8 offset:1280
    v_mfma_f32_32x32x16_bf16 v[64:79], a[96:99], a[72:75], v[64:79]
    ds_read_b128 a[68:71], v16
    ds_read_b64_tr_b16 a[84:85], v8 offset:40
    ds_read_b64_tr_b16 a[86:87], v8 offset:1320
    v_mfma_f32_32x32x16_bf16 v[96:111], a[96:99], a[76:79], v[96:111]
    ds_read_b64_tr_b16 a[88:89], v3 offset:0
    ds_read_b64_tr_b16 a[90:91], v3 offset:1280
    s_add_u32 m0, s43, s48
    v_add_u32 v5, s46, v5
    v_add_u32 v6, s46, v6
    v_add_u32 v7, s46, v7
    buffer_load_dwordx4 v20, s[20:23], 0 offen offset:0 lds
    v_mfma_f32_32x32x16_bf16 v[112:127], a[100:103], a[72:75], v[112:127]
    v_add_u32 v17, s46, v17
    v_add_u32 v18, s46, v18
    v_add_u32 v19, s46, v19
    buffer_load_dwordx4 v21, s[20:23], 0 offen offset:1024 lds
    s_add_u32 s44, s44, 1
    s_cmp_lt_u32 s44, 9
    s_cbranch_scc1 P1_QK_LOOP
    v_mov_b32 v128, 0
    global_load_dword v147, v128, s[32:33] sc1
    ds_read_b128 a[104:107], v5
    ds_read_b64_tr_b16 a[112:113], v8 offset:5120
    ds_read_b64_tr_b16 a[114:115], v8 offset:6400
    s_waitcnt lgkmcnt(8)
    v_mfma_f32_32x32x16_bf16 v[48:63], a[80:83], a[64:67], v[48:63]
    ds_read_b128 a[124:127], v6
    ds_read_b64_tr_b16 a[132:133], v8 offset:10240
    ds_read_b64_tr_b16 a[134:135], v8 offset:11520
    s_waitcnt lgkmcnt(3)
    v_mfma_f32_32x32x16_bf16 v[48:63], a[112:115], a[104:107], v[48:63]
    ds_read_b128 a[144:147], v7
    ds_read_b64_tr_b16 a[152:153], v8 offset:15360
    ds_read_b64_tr_b16 a[154:155], v8 offset:16640
    s_waitcnt lgkmcnt(3)
    v_mfma_f32_32x32x16_bf16 v[48:63], a[132:135], a[124:127], v[48:63]
    ds_read_b128 a[108:111], v17
    ds_read_b128 a[128:131], v18
    ds_read_b128 a[148:151], v19
    s_waitcnt lgkmcnt(3)
    v_mfma_f32_32x32x16_bf16 v[48:63], a[152:155], a[144:147], v[48:63]
    ds_read_b64_tr_b16 a[116:117], v8 offset:5160
    ds_read_b64_tr_b16 a[118:119], v8 offset:6440
    ds_read_b64_tr_b16 a[136:137], v8 offset:10280
    v_mfma_f32_32x32x16_bf16 v[80:95], a[80:83], a[68:71], v[80:95]
    ds_read_b64_tr_b16 a[138:139], v8 offset:11560
    ds_read_b64_tr_b16 a[156:157], v8 offset:15400
    ds_read_b64_tr_b16 a[158:159], v8 offset:16680
    s_waitcnt lgkmcnt(8)
    v_mfma_f32_32x32x16_bf16 v[80:95], a[112:115], a[108:111], v[80:95]
    ds_read_b64_tr_b16 a[120:121], v3 offset:5120
    ds_read_b64_tr_b16 a[122:123], v3 offset:6400
    ds_read_b64_tr_b16 a[140:141], v3 offset:10240
    s_waitcnt lgkmcnt(10)
    v_mfma_f32_32x32x16_bf16 v[80:95], a[132:135], a[128:131], v[80:95]
    ds_read_b64_tr_b16 a[142:143], v3 offset:11520
    ds_read_b64_tr_b16 a[160:161], v3 offset:15360
    ds_read_b64_tr_b16 a[162:163], v3 offset:16640
    v_pk_mul_f32 v[48:49], v[48:49], s[50:51]
    v_pk_mul_f32 v[50:51], v[50:51], s[50:51]
    v_pk_mul_f32 v[52:53], v[52:53], s[50:51]
    v_pk_mul_f32 v[54:55], v[54:55], s[50:51]
    s_add_u32 s59, s60, 0x0
    s_waitcnt lgkmcnt(12)
    v_mfma_f32_32x32x16_bf16 v[80:95], a[152:155], a[148:151], v[80:95]
    v_cvt_pk_bf16_f32 v20, v48, v49
    v_cvt_pk_bf16_f32 v21, v50, v51
    v_cvt_pk_bf16_f32 v22, v52, v53
    v_cvt_pk_bf16_f32 v23, v54, v55
    buffer_store_dwordx4 v[20:23], v10, s[28:31], s59 offen sc1
    v_mfma_f32_32x32x16_bf16 v[64:79], a[84:87], a[64:67], v[64:79]
    v_pk_mul_f32 v[56:57], v[56:57], s[50:51]
    v_pk_mul_f32 v[58:59], v[58:59], s[50:51]
    v_pk_mul_f32 v[60:61], v[60:61], s[50:51]
    v_pk_mul_f32 v[62:63], v[62:63], s[50:51]
    s_add_u32 s59, s60, 0x50000
    s_waitcnt lgkmcnt(10)
    v_mfma_f32_32x32x16_bf16 v[64:79], a[116:119], a[104:107], v[64:79]
    v_cvt_pk_bf16_f32 v24, v56, v57
    v_cvt_pk_bf16_f32 v25, v58, v59
    v_cvt_pk_bf16_f32 v26, v60, v61
    v_cvt_pk_bf16_f32 v27, v62, v63
    buffer_store_dwordx4 v[24:27], v10, s[28:31], s59 offen sc1
    s_waitcnt lgkmcnt(8)
    v_mfma_f32_32x32x16_bf16 v[64:79], a[136:139], a[124:127], v[64:79]
    v_pk_mul_f32 v[80:81], v[80:81], s[50:51]
    v_pk_mul_f32 v[82:83], v[82:83], s[50:51]
    v_pk_mul_f32 v[84:85], v[84:85], s[50:51]
    v_pk_mul_f32 v[86:87], v[86:87], s[50:51]
    s_add_u32 s59, s61, 0x0
    s_waitcnt lgkmcnt(6)
    v_mfma_f32_32x32x16_bf16 v[64:79], a[156:159], a[144:147], v[64:79]
    v_cvt_pk_bf16_f32 v28, v80, v81
    v_cvt_pk_bf16_f32 v29, v82, v83
    v_cvt_pk_bf16_f32 v30, v84, v85
    v_cvt_pk_bf16_f32 v31, v86, v87
    buffer_store_dwordx4 v[28:31], v10, s[28:31], s59 offen sc1
    v_mfma_f32_32x32x16_bf16 v[96:111], a[84:87], a[68:71], v[96:111]
    v_pk_mul_f32 v[88:89], v[88:89], s[50:51]
    v_pk_mul_f32 v[90:91], v[90:91], s[50:51]
    v_pk_mul_f32 v[92:93], v[92:93], s[50:51]
    v_pk_mul_f32 v[94:95], v[94:95], s[50:51]
    s_add_u32 s59, s61, 0x50000
    s_waitcnt lgkmcnt(10)
    v_mfma_f32_32x32x16_bf16 v[96:111], a[116:119], a[108:111], v[96:111]
    v_cvt_pk_bf16_f32 v32, v88, v89
    v_cvt_pk_bf16_f32 v33, v90, v91
    v_cvt_pk_bf16_f32 v34, v92, v93
    v_cvt_pk_bf16_f32 v35, v94, v95
    buffer_store_dwordx4 v[32:35], v10, s[28:31], s59 offen sc1
    s_waitcnt lgkmcnt(8)
    v_mfma_f32_32x32x16_bf16 v[96:111], a[136:139], a[128:131], v[96:111]
    v_pk_mul_f32 v[64:65], v[64:65], s[50:51]
    v_pk_mul_f32 v[66:67], v[66:67], s[50:51]
    v_pk_mul_f32 v[68:69], v[68:69], s[50:51]
    v_pk_mul_f32 v[70:71], v[70:71], s[50:51]
    s_add_u32 s59, s60, 0x14000
    s_waitcnt lgkmcnt(6)
    v_mfma_f32_32x32x16_bf16 v[96:111], a[156:159], a[148:151], v[96:111]
    v_cvt_pk_bf16_f32 v36, v64, v65
    v_cvt_pk_bf16_f32 v37, v66, v67
    v_cvt_pk_bf16_f32 v38, v68, v69
    v_cvt_pk_bf16_f32 v39, v70, v71
    buffer_store_dwordx4 v[36:39], v10, s[28:31], s59 offen sc1
    v_mfma_f32_32x32x16_bf16 v[112:127], a[88:91], a[64:67], v[112:127]
    v_pk_mul_f32 v[72:73], v[72:73], s[50:51]
    v_pk_mul_f32 v[74:75], v[74:75], s[50:51]
    v_pk_mul_f32 v[76:77], v[76:77], s[50:51]
    v_pk_mul_f32 v[78:79], v[78:79], s[50:51]
    s_add_u32 s59, s60, 0x64000
    s_waitcnt lgkmcnt(4)
    v_mfma_f32_32x32x16_bf16 v[112:127], a[120:123], a[104:107], v[112:127]
    v_cvt_pk_bf16_f32 v40, v72, v73
    v_cvt_pk_bf16_f32 v41, v74, v75
    v_cvt_pk_bf16_f32 v42, v76, v77
    v_cvt_pk_bf16_f32 v43, v78, v79
    buffer_store_dwordx4 v[40:43], v10, s[28:31], s59 offen sc1
    s_waitcnt lgkmcnt(2)
    v_mfma_f32_32x32x16_bf16 v[112:127], a[140:143], a[124:127], v[112:127]
    v_pk_mul_f32 v[96:97], v[96:97], s[50:51]
    v_pk_mul_f32 v[98:99], v[98:99], s[50:51]
    v_pk_mul_f32 v[100:101], v[100:101], s[50:51]
    v_pk_mul_f32 v[102:103], v[102:103], s[50:51]
    s_add_u32 s59, s61, 0x14000
    s_waitcnt lgkmcnt(0)
    v_mfma_f32_32x32x16_bf16 v[112:127], a[160:163], a[144:147], v[112:127]
    v_cvt_pk_bf16_f32 v44, v96, v97
    v_cvt_pk_bf16_f32 v45, v98, v99
    v_cvt_pk_bf16_f32 v46, v100, v101
    v_cvt_pk_bf16_f32 v47, v102, v103
    buffer_store_dwordx4 v[44:47], v10, s[28:31], s59 offen sc1
    v_pk_mul_f32 v[104:105], v[104:105], s[50:51]
    v_pk_mul_f32 v[106:107], v[106:107], s[50:51]
    v_pk_mul_f32 v[108:109], v[108:109], s[50:51]
    v_pk_mul_f32 v[110:111], v[110:111], s[50:51]
    s_add_u32 s59, s61, 0x64000
    v_cvt_pk_bf16_f32 v20, v104, v105
    v_cvt_pk_bf16_f32 v21, v106, v107
    v_cvt_pk_bf16_f32 v22, v108, v109
    v_cvt_pk_bf16_f32 v23, v110, v111
    buffer_store_dwordx4 v[20:23], v10, s[28:31], s59 offen sc1
    v_pk_mul_f32 v[112:113], v[112:113], s[50:51]
    v_pk_mul_f32 v[114:115], v[114:115], s[50:51]
    s_add_u32 s59, s55, 0x0
    v_cvt_pk_bf16_f32 v24, v112, v113
    v_cvt_pk_bf16_f32 v25, v114, v115
    buffer_store_dwordx2 v[24:25], v11, s[28:31], s59 offen offset:1024 sc1
    v_pk_mul_f32 v[116:117], v[116:117], s[50:51]
    v_pk_mul_f32 v[118:119], v[118:119], s[50:51]
    s_add_u32 s59, s55, 0x28000
    v_cvt_pk_bf16_f32 v28, v116, v117
    v_cvt_pk_bf16_f32 v29, v118, v119
    buffer_store_dwordx2 v[28:29], v11, s[28:31], s59 offen offset:1024 sc1
    v_pk_mul_f32 v[120:121], v[120:121], s[50:51]
    v_pk_mul_f32 v[122:123], v[122:123], s[50:51]
    s_add_u32 s59, s55, 0x50000
    v_cvt_pk_bf16_f32 v32, v120, v121
    v_cvt_pk_bf16_f32 v33, v122, v123
    buffer_store_dwordx2 v[32:33], v11, s[28:31], s59 offen offset:1024 sc1
    v_pk_mul_f32 v[124:125], v[124:125], s[50:51]
    v_pk_mul_f32 v[126:127], v[126:127], s[50:51]
    s_add_u32 s59, s55, 0x78000
    v_cvt_pk_bf16_f32 v36, v124, v125
    v_cvt_pk_bf16_f32 v37, v126, v127
    buffer_store_dwordx2 v[36:37], v11, s[28:31], s59 offen offset:1024 sc1
    s_branch P2_SETUP
P1_V:
    v_lshl_add_u32 v8, v13, 3, v12
    s_add_u32 s55, s55, 0x510000
    s_add_u32 s56, s56, 0x510000
    s_add_u32 s60, s55, s58
    s_add_u32 s61, s56, s58
    s_mov_b32 s52, 327680
    v_and_b32 v10, 15, v1
    v_lshlrev_b32 v10, 4, v10
    v_lshl_add_u32 v10, v2, 8, v10
    v_mad_u32_u24 v10, v14, s52, v10
    v_lshlrev_b32 v11, 4, v13
    v_lshl_add_u32 v11, v2, 6, v11
    v_lshrrev_b32 v12, 2, v1
    v_and_b32 v12, 7, v12
    v_mad_u32_u24 v11, v12, s57, v11
    s_waitcnt vmcnt(4)
    s_barrier
    ds_read_b128 a[64:67], v4
    ds_read_b64_tr_b16 a[80:81], v8 offset:0
    ds_read_b64_tr_b16 a[82:83], v8 offset:1280
    ds_read_b128 a[68:71], v16
    ds_read_b64_tr_b16 a[84:85], v8 offset:40
    ds_read_b64_tr_b16 a[86:87], v8 offset:1320
    ds_read_b64_tr_b16 a[88:89], v3 offset:0
    ds_read_b64_tr_b16 a[90:91], v3 offset:1280
    s_add_u32 m0, s43, s49
    s_nop 0
    buffer_load_dwordx4 v24, s[24:27], 0 offen offset:0 lds
    buffer_load_dwordx4 v25, s[24:27], 0 offen offset:1024 lds
    buffer_load_dwordx4 v26, s[24:27], 0 offen offset:2048 lds
    buffer_load_dwordx4 v27, s[24:27], 0 offen offset:3072 lds
    s_add_u32 m0, s43, s63
    s_nop 0
    buffer_load_dwordx4 v28, s[24:27], 0 offen offset:0 lds
    s_add_u32 s47, s47, 1
    s_cmp_eq_u32 s47, 10
    s_cselect_b32 s47, 0, s47
    s_cselect_b32 s64, s66, s67
    s_cselect_b32 s65, s68, s69
    s_cselect_b32 s62, -1, 0
    s_add_u32 s20, s20, s64
    s_addc_u32 s21, s21, s62
    s_add_u32 s24, s24, s65
    s_addc_u32 s25, s25, s62
    s_mov_b32 s43, 73728
    s_add_u32 m0, s43, s48
    s_mov_b32 s44, 0
    buffer_load_dwordx4 v20, s[20:23], 0 offen offset:0 lds
    buffer_load_dwordx4 v21, s[20:23], 0 offen offset:1024 lds
.p2align 6
P1_V_LOOP:
    s_waitcnt lgkmcnt(5)
    v_mfma_f32_32x32x16_bf16 v[48:63], a[64:67], a[80:83], v[48:63]
    s_waitcnt lgkmcnt(4)
    ds_read_b128 a[72:75], v5
    ds_read_b64_tr_b16 a[92:93], v8 offset:5120
    v_mfma_f32_32x32x16_bf16 v[80:95], a[68:71], a[80:83], v[80:95]
    s_waitcnt lgkmcnt(4)
    ds_read_b64_tr_b16 a[94:95], v8 offset:6400
    ds_read_b128 a[76:79], v17
    v_mfma_f32_32x32x16_bf16 v[64:79], a[64:67], a[84:87], v[64:79]
    ds_read_b64_tr_b16 a[96:97], v8 offset:5160
    ds_read_b64_tr_b16 a[98:99], v8 offset:6440
    buffer_load_dwordx4 v22, s[20:23], 0 offen offset:2048 lds
    v_mfma_f32_32x32x16_bf16 v[96:111], a[68:71], a[84:87], v[96:111]
    s_waitcnt lgkmcnt(6)
    ds_read_b64_tr_b16 a[100:101], v3 offset:5120
    ds_read_b64_tr_b16 a[102:103], v3 offset:6400
    buffer_load_dwordx4 v23, s[20:23], 0 offen offset:3072 lds
    s_add_u32 m0, s43, s49
    v_mfma_f32_32x32x16_bf16 v[112:127], a[64:67], a[88:91], v[112:127]
    buffer_load_dwordx4 v24, s[24:27], 0 offen offset:0 lds
    s_waitcnt lgkmcnt(5)
    v_mfma_f32_32x32x16_bf16 v[48:63], a[72:75], a[92:95], v[48:63]
    s_waitcnt lgkmcnt(4)
    ds_read_b128 a[64:67], v6
    ds_read_b64_tr_b16 a[80:81], v8 offset:10240
    v_mfma_f32_32x32x16_bf16 v[80:95], a[76:79], a[92:95], v[80:95]
    s_waitcnt lgkmcnt(4)
    ds_read_b64_tr_b16 a[82:83], v8 offset:11520
    ds_read_b128 a[68:71], v18
    v_mfma_f32_32x32x16_bf16 v[64:79], a[72:75], a[96:99], v[64:79]
    ds_read_b64_tr_b16 a[84:85], v8 offset:10280
    ds_read_b64_tr_b16 a[86:87], v8 offset:11560
    buffer_load_dwordx4 v25, s[24:27], 0 offen offset:1024 lds
    v_mfma_f32_32x32x16_bf16 v[96:111], a[76:79], a[96:99], v[96:111]
    s_waitcnt lgkmcnt(6)
    ds_read_b64_tr_b16 a[88:89], v3 offset:10240
    ds_read_b64_tr_b16 a[90:91], v3 offset:11520
    buffer_load_dwordx4 v26, s[24:27], 0 offen offset:2048 lds
    v_mfma_f32_32x32x16_bf16 v[112:127], a[72:75], a[100:103], v[112:127]
    buffer_load_dwordx4 v27, s[24:27], 0 offen offset:3072 lds
    s_waitcnt lgkmcnt(5)
    v_mfma_f32_32x32x16_bf16 v[48:63], a[64:67], a[80:83], v[48:63]
    s_waitcnt lgkmcnt(4)
    ds_read_b128 a[72:75], v7
    ds_read_b64_tr_b16 a[92:93], v8 offset:15360
    v_mfma_f32_32x32x16_bf16 v[80:95], a[68:71], a[80:83], v[80:95]
    s_waitcnt lgkmcnt(4)
    ds_read_b64_tr_b16 a[94:95], v8 offset:16640
    ds_read_b128 a[76:79], v19
    s_add_u32 m0, s43, s63
    v_mfma_f32_32x32x16_bf16 v[64:79], a[64:67], a[84:87], v[64:79]
    ds_read_b64_tr_b16 a[96:97], v8 offset:15400
    ds_read_b64_tr_b16 a[98:99], v8 offset:16680
    buffer_load_dwordx4 v28, s[24:27], 0 offen offset:0 lds
    v_mfma_f32_32x32x16_bf16 v[96:111], a[68:71], a[84:87], v[96:111]
    s_waitcnt lgkmcnt(6)
    ds_read_b64_tr_b16 a[100:101], v3 offset:15360
    ds_read_b64_tr_b16 a[102:103], v3 offset:16640
    v_mfma_f32_32x32x16_bf16 v[112:127], a[64:67], a[88:91], v[112:127]
    s_add_u32 s47, s47, 1
    s_cmp_eq_u32 s47, 10
    s_cselect_b32 s47, 0, s47
    s_cselect_b32 s64, s66, s67
    s_cselect_b32 s65, s68, s69
    s_cselect_b32 s62, -1, 0
    s_add_u32 s20, s20, s64
    s_addc_u32 s21, s21, s62
    s_add_u32 s24, s24, s65
    s_addc_u32 s25, s25, s62
    s_cmp_ge_u32 s44, 7
    s_cselect_b32 s22, 0, s22
    s_cselect_b32 s26, 0, s26
    s_waitcnt lgkmcnt(0)
    v_mfma_f32_32x32x16_bf16 v[48:63], a[72:75], a[92:95], v[48:63]
    s_mov_b32 s43, s45
    s_add_u32 s45, s45, 36864
    s_cmp_eq_u32 s45, 110592
    s_cselect_b32 s45, 0, s45
    s_cselect_b32 s46, s70, s71
    v_add_u32 v4, s46, v4
    v_add_u32 v8, s46, v8
    v_add_u32 v16, s46, v16
    v_add_u32 v3, s46, v3
    s_waitcnt vmcnt(9)
    s_barrier
P1_V_LOOP_NB:
    v_mfma_f32_32x32x16_bf16 v[80:95], a[76:79], a[92:95], v[80:95]
    ds_read_b128 a[64:67], v4
    ds_read_b64_tr_b16 a[80:81], v8 offset:0
    ds_read_b64_tr_b16 a[82:83], v8 offset:1280
    v_mfma_f32_32x32x16_bf16 v[64:79], a[72:75], a[96:99], v[64:79]
    ds_read_b128 a[68:71], v16
    ds_read_b64_tr_b16 a[84:85], v8 offset:40
    ds_read_b64_tr_b16 a[86:87], v8 offset:1320
    v_mfma_f32_32x32x16_bf16 v[96:111], a[76:79], a[96:99], v[96:111]
    ds_read_b64_tr_b16 a[88:89], v3 offset:0
    ds_read_b64_tr_b16 a[90:91], v3 offset:1280
    s_add_u32 m0, s43, s48
    v_add_u32 v5, s46, v5
    v_add_u32 v6, s46, v6
    v_add_u32 v7, s46, v7
    buffer_load_dwordx4 v20, s[20:23], 0 offen offset:0 lds
    v_mfma_f32_32x32x16_bf16 v[112:127], a[72:75], a[100:103], v[112:127]
    v_add_u32 v17, s46, v17
    v_add_u32 v18, s46, v18
    v_add_u32 v19, s46, v19
    buffer_load_dwordx4 v21, s[20:23], 0 offen offset:1024 lds
    s_add_u32 s44, s44, 1
    s_cmp_lt_u32 s44, 9
    s_cbranch_scc1 P1_V_LOOP
    v_mov_b32 v128, 0
    global_load_dword v147, v128, s[32:33] sc1
    ds_read_b128 a[104:107], v5
    ds_read_b64_tr_b16 a[112:113], v8 offset:5120
    ds_read_b64_tr_b16 a[114:115], v8 offset:6400
    s_waitcnt lgkmcnt(8)
    v_mfma_f32_32x32x16_bf16 v[48:63], a[64:67], a[80:83], v[48:63]
    ds_read_b128 a[124:127], v6
    ds_read_b64_tr_b16 a[132:133], v8 offset:10240
    ds_read_b64_tr_b16 a[134:135], v8 offset:11520
    s_waitcnt lgkmcnt(3)
    v_mfma_f32_32x32x16_bf16 v[48:63], a[104:107], a[112:115], v[48:63]
    ds_read_b128 a[144:147], v7
    ds_read_b64_tr_b16 a[152:153], v8 offset:15360
    ds_read_b64_tr_b16 a[154:155], v8 offset:16640
    s_waitcnt lgkmcnt(3)
    v_mfma_f32_32x32x16_bf16 v[48:63], a[124:127], a[132:135], v[48:63]
    ds_read_b128 a[108:111], v17
    ds_read_b128 a[128:131], v18
    ds_read_b128 a[148:151], v19
    s_waitcnt lgkmcnt(3)
    v_mfma_f32_32x32x16_bf16 v[48:63], a[144:147], a[152:155], v[48:63]
    ds_read_b64_tr_b16 a[116:117], v8 offset:5160
    ds_read_b64_tr_b16 a[118:119], v8 offset:6440
    ds_read_b64_tr_b16 a[136:137], v8 offset:10280
    v_mfma_f32_32x32x16_bf16 v[80:95], a[68:71], a[80:83], v[80:95]
    ds_read_b64_tr_b16 a[138:139], v8 offset:11560
    ds_read_b64_tr_b16 a[156:157], v8 offset:15400
    ds_read_b64_tr_b16 a[158:159], v8 offset:16680
    s_waitcnt lgkmcnt(8)
    v_mfma_f32_32x32x16_bf16 v[80:95], a[108:111], a[112:115], v[80:95]
    ds_read_b64_tr_b16 a[120:121], v3 offset:5120
    ds_read_b64_tr_b16 a[122:123], v3 offset:6400
    ds_read_b64_tr_b16 a[140:141], v3 offset:10240
    s_waitcnt lgkmcnt(10)
    v_mfma_f32_32x32x16_bf16 v[80:95], a[128:131], a[132:135], v[80:95]
    ds_read_b64_tr_b16 a[142:143], v3 offset:11520
    ds_read_b64_tr_b16 a[160:161], v3 offset:15360
    ds_read_b64_tr_b16 a[162:163], v3 offset:16640
    v_cvt_pk_bf16_f32 v40, v48, v49
    v_cvt_pk_bf16_f32 v41, v50, v51
    v_cvt_pk_bf16_f32 v42, v52, v53
    v_cvt_pk_bf16_f32 v43, v54, v55
    s_add_u32 s59, s60, 0x0
    s_waitcnt lgkmcnt(12)
    v_mfma_f32_32x32x16_bf16 v[80:95], a[148:151], a[152:155], v[80:95]
    buffer_store_dwordx4 v[40:43], v10, s[28:31], s59 offen offset:0 sc1
    v_cvt_pk_bf16_f32 v44, v56, v57
    v_cvt_pk_bf16_f32 v45, v58, v59
    v_cvt_pk_bf16_f32 v46, v60, v61
    v_cvt_pk_bf16_f32 v47, v62, v63
    v_mfma_f32_32x32x16_bf16 v[64:79], a[64:67], a[84:87], v[64:79]
    buffer_store_dwordx4 v[44:47], v10, s[28:31], s59 offen offset:640 sc1
    s_waitcnt lgkmcnt(10)
    v_mfma_f32_32x32x16_bf16 v[64:79], a[104:107], a[116:119], v[64:79]
    s_waitcnt lgkmcnt(8)
    v_mfma_f32_32x32x16_bf16 v[64:79], a[124:127], a[136:139], v[64:79]
    s_nop 0
    v_cvt_pk_bf16_f32 v20, v80, v81
    v_cvt_pk_bf16_f32 v21, v82, v83
    v_cvt_pk_bf16_f32 v22, v84, v85
    v_cvt_pk_bf16_f32 v23, v86, v87
    s_add_u32 s59, s61, 0x0
    s_waitcnt lgkmcnt(6)
    v_mfma_f32_32x32x16_bf16 v[64:79], a[144:147], a[156:159], v[64:79]
    buffer_store_dwordx4 v[20:23], v10, s[28:31], s59 offen offset:0 sc1
    v_cvt_pk_bf16_f32 v24, v88, v89
    v_cvt_pk_bf16_f32 v25, v90, v91
    v_cvt_pk_bf16_f32 v26, v92, v93
    v_cvt_pk_bf16_f32 v27, v94, v95
    v_mfma_f32_32x32x16_bf16 v[96:111], a[68:71], a[84:87], v[96:111]
    buffer_store_dwordx4 v[24:27], v10, s[28:31], s59 offen offset:640 sc1
    s_waitcnt lgkmcnt(10)
    v_mfma_f32_32x32x16_bf16 v[96:111], a[108:111], a[116:119], v[96:111]
    s_waitcnt lgkmcnt(8)
    v_mfma_f32_32x32x16_bf16 v[96:111], a[128:131], a[136:139], v[96:111]
    s_nop 0
    v_cvt_pk_bf16_f32 v28, v64, v65
    v_cvt_pk_bf16_f32 v29, v66, v67
    v_cvt_pk_bf16_f32 v30, v68, v69
    v_cvt_pk_bf16_f32 v31, v70, v71
    s_add_u32 s59, s60, 0x14000
    s_waitcnt lgkmcnt(6)
    v_mfma_f32_32x32x16_bf16 v[96:111], a[148:151], a[156:159], v[96:111]
    buffer_store_dwordx4 v[28:31], v10, s[28:31], s59 offen offset:0 sc1
    v_cvt_pk_bf16_f32 v32, v72, v73
    v_cvt_pk_bf16_f32 v33, v74, v75
    v_cvt_pk_bf16_f32 v34, v76, v77
    v_cvt_pk_bf16_f32 v35, v78, v79
    v_mfma_f32_32x32x16_bf16 v[112:127], a[64:67], a[88:91], v[112:127]
    buffer_store_dwordx4 v[32:35], v10, s[28:31], s59 offen offset:640 sc1
    s_waitcnt lgkmcnt(4)
    v_mfma_f32_32x32x16_bf16 v[112:127], a[104:107], a[120:123], v[112:127]
    s_waitcnt lgkmcnt(2)
    v_mfma_f32_32x32x16_bf16 v[112:127], a[124:127], a[140:143], v[112:127]
    s_nop 0
    v_cvt_pk_bf16_f32 v36, v96, v97
    v_cvt_pk_bf16_f32 v37, v98, v99
    v_cvt_pk_bf16_f32 v38, v100, v101
    v_cvt_pk_bf16_f32 v39, v102, v103
    s_add_u32 s59, s61, 0x14000
    s_waitcnt lgkmcnt(0)
    v_mfma_f32_32x32x16_bf16 v[112:127], a[144:147], a[160:163], v[112:127]
    buffer_store_dwordx4 v[36:39], v10, s[28:31], s59 offen offset:0 sc1
    v_cvt_pk_bf16_f32 v40, v104, v105
    v_cvt_pk_bf16_f32 v41, v106, v107
    v_cvt_pk_bf16_f32 v42, v108, v109
    v_cvt_pk_bf16_f32 v43, v110, v111
    buffer_store_dwordx4 v[40:43], v10, s[28:31], s59 offen offset:640 sc1
    s_nop 5
    v_cvt_pk_bf16_f32 v44, v112, v113
    v_cvt_pk_bf16_f32 v45, v114, v115
    v_cvt_pk_bf16_f32 v46, v116, v117
    v_cvt_pk_bf16_f32 v47, v118, v119
    buffer_store_dwordx4 v[44:47], v11, s[28:31], s55 offen offset:512 sc1
    v_cvt_pk_bf16_f32 v20, v120, v121
    v_cvt_pk_bf16_f32 v21, v122, v123
    v_cvt_pk_bf16_f32 v22, v124, v125
    v_cvt_pk_bf16_f32 v23, v126, v127
    buffer_store_dwordx4 v[20:23], v11, s[28:31], s55 offen offset:1152 sc1
    s_branch P2_SETUP
P1_AUX:
    s_load_dwordx2 s[44:45], s[0:1], 72
    s_sub_u32 s40, s40, 24
    s_lshl_b32 s46, s40, 2
    s_and_b32 s47, s39, 3
    s_add_u32 s46, s46, s47
    s_lshr_b32 s47, s39, 2
    s_lshl_b32 s47, s47, 5
    s_add_u32 s47, s47, s46
    s_lshl_b32 s40, s40, 3
    s_add_u32 s40, s40, s39
    v_lshlrev_b32 v3, 4, v1
    s_mul_i32 s41, s47, 40960
    s_mul_i32 s42, s36, 10240
    s_add_u32 s41, s41, s42
    s_lshl_b32 s58, s40, 2
    s_add_u32 s58, s58, s36
    v_mov_b32 v147, 0x7f000000
    v_cmp_gt_u32 vcc, 8, v1
    v_pk_mov_b32 v[152:153], 0, 0
    v_pk_mov_b32 v[154:155], 0, 0
    v_cndmask_b32 v146, v147, v3, vcc
    v_mov_b32 v148, 0x3f803f80
    v_mov_b32 v149, 0x3f803f80
    v_mov_b32 v150, 0x3f803f80
    v_mov_b32 v151, 0x3f803f80
    s_mul_i32 s57, s58, 1152
    s_add_u32 s57, s57, 0x1490000
    s_lshl_b32 s56, s58, 10
    s_add_u32 s56, s56, 0x50e000
    s_cmp_lt_u32 s58, 8
    s_cselect_b32 s56, s56, 0x7f000000
    s_waitcnt lgkmcnt(0)
    s_mov_b32 s20, s4
    s_mov_b32 s21, s5
    s_mov_b32 s22, 0x280000
    s_mov_b32 s23, 0x00020000
    s_mov_b32 s24, s18
    s_mov_b32 s25, s19
    s_mov_b32 s26, 0x500
    s_mov_b32 s27, 0x00020000
    s_mov_b32 s28, s10
    s_mov_b32 s29, s11
    s_mov_b32 s30, 0x2000000
    s_mov_b32 s31, 0x00020000
    buffer_store_dwordx4 v[152:155], v3, s[28:31], s57 offen sc1
    buffer_store_dwordx4 v[152:155], v146, s[28:31], s57 offen offset:1024 sc1
    buffer_store_dwordx4 v[148:151], v3, s[28:31], s56 offen sc1
    s_add_u32 m0, s42, 0
    s_add_u32 s43, s41, 0
    buffer_load_dwordx4 v3, s[20:23], s43 offen offset:0 lds
    buffer_load_dwordx4 v3, s[20:23], s43 offen offset:1024 lds
    buffer_load_dwordx4 v3, s[20:23], s43 offen offset:2048 lds
    buffer_load_dwordx4 v3, s[20:23], s43 offen offset:3072 lds
    s_add_u32 m0, s42, 4096
    s_add_u32 s43, s41, 4096
    buffer_load_dwordx4 v3, s[20:23], s43 offen offset:0 lds
    buffer_load_dwordx4 v3, s[20:23], s43 offen offset:1024 lds
    buffer_load_dwordx4 v3, s[20:23], s43 offen offset:2048 lds
    buffer_load_dwordx4 v3, s[20:23], s43 offen offset:3072 lds
    s_add_u32 m0, s42, 8192
    s_add_u32 s43, s41, 8192
    buffer_load_dwordx4 v3, s[20:23], s43 offen offset:0 lds
    buffer_load_dwordx4 v3, s[20:23], s43 offen offset:1024 lds
    s_mov_b32 m0, 40960
    s_nop 0
    buffer_load_dwordx4 v3, s[24:27], 0 offen lds
    buffer_load_dwordx4 v3, s[24:27], 0 offen offset:1024 lds
    v_lshlrev_b32 v4, 2, v1
    v_and_b32 v5, 15, v1
    v_lshlrev_b32 v5, 5, v5
    v_lshrrev_b32 v6, 4, v1
    s_mov_b32 s35, 0x00020000
    s_add_u32 s59, s58, 0
    s_min_u32 s59, s59, 679
    s_cmp_lt_u32 s59, 480
    s_cselect_b32 s32, s16, s8
    s_cselect_b32 s33, s17, s9
    s_mov_b32 s34, 819200
    s_cmov_b32 s34, 1966080
    s_cselect_b32 s60, 0, 480
    s_cselect_b32 s46, 96, 40
    s_mov_b32 s62, 0x6666667
    s_cmov_b32 s62, 0x2aaaaab
    s_cselect_b32 s67, 16, 20
    s_cselect_b32 s50, 8, 4
    s_cselect_b32 s51, 4, 8
    s_cselect_b32 s52, 1000, 32
    s_mov_b32 s43, 0x1198000
    s_cmov_b32 s43, 0x1180000
    s_sub_u32 s60, s59, s60
    s_mul_hi_u32 s63, s60, s62
    s_mul_i32 s61, s63, s46
    s_sub_u32 s60, s60, s61
    s_mul_i32 s48, s63, 544
    s_add_u32 s48, s48, s60
    s_lshl_b32 s48, s48, 10
    s_add_u32 s64, s48, s43
    s_mov_b32 s68, 139264
    s_mul_i32 s61, s60, s67
    s_mul_i32 s53, s60, 80
    s_sub_u32 s53, s53, 2544
    s_cmp_ge_u32 s60, s52
    s_cselect_b32 s61, s53, s61
    s_cselect_b32 s50, 40, s50
    s_cselect_b32 s51, 20, s51
    s_mul_i32 s60, s61, 1280
    s_lshl_b32 s63, s63, 8
    s_add_u32 s60, s60, s63
    s_mul_i32 s51, s51, 1280
    s_mul_i32 s50, s50, 1280
    s_add_u32 s61, s60, s51
    s_add_u32 s62, s60, s50
    s_add_u32 s63, s62, s51
    buffer_load_dword v16, v4, s[32:35], s60 offen offset:0
    buffer_load_dword v17, v4, s[32:35], s60 offen offset:1280
    buffer_load_dword v18, v4, s[32:35], s60 offen offset:2560
    buffer_load_dword v19, v4, s[32:35], s60 offen offset:3840
    buffer_load_dword v20, v4, s[32:35], s61 offen offset:0
    buffer_load_dword v21, v4, s[32:35], s61 offen offset:1280
    buffer_load_dword v22, v4, s[32:35], s61 offen offset:2560
    buffer_load_dword v23, v4, s[32:35], s61 offen offset:3840
    buffer_load_dword v24, v4, s[32:35], s62 offen offset:0
    buffer_load_dword v25, v4, s[32:35], s62 offen offset:1280
    buffer_load_dword v26, v4, s[32:35], s62 offen offset:2560
    buffer_load_dword v27, v4, s[32:35], s62 offen offset:3840
    buffer_load_dword v28, v4, s[32:35], s63 offen offset:0
    buffer_load_dword v29, v4, s[32:35], s63 offen offset:1280
    buffer_load_dword v30, v4, s[32:35], s63 offen offset:2560
    buffer_load_dword v31, v4, s[32:35], s63 offen offset:3840
    s_add_u32 s59, s58, 256
    s_min_u32 s59, s59, 679
    s_cmp_lt_u32 s59, 480
    s_cselect_b32 s32, s16, s8
    s_cselect_b32 s33, s17, s9
    s_mov_b32 s34, 819200
    s_cmov_b32 s34, 1966080
    s_cselect_b32 s60, 0, 480
    s_cselect_b32 s46, 96, 40
    s_mov_b32 s62, 0x6666667
    s_cmov_b32 s62, 0x2aaaaab
    s_cselect_b32 s67, 16, 20
    s_cselect_b32 s50, 8, 4
    s_cselect_b32 s51, 4, 8
    s_cselect_b32 s52, 1000, 32
    s_mov_b32 s43, 0x1198000
    s_cmov_b32 s43, 0x1180000
    s_sub_u32 s60, s59, s60
    s_mul_hi_u32 s63, s60, s62
    s_mul_i32 s61, s63, s46
    s_sub_u32 s60, s60, s61
    s_mul_i32 s48, s63, 544
    s_add_u32 s48, s48, s60
    s_lshl_b32 s48, s48, 10
    s_add_u32 s65, s48, s43
    s_mov_b32 s69, 139264
    s_mul_i32 s61, s60, s67
    s_mul_i32 s53, s60, 80
    s_sub_u32 s53, s53, 2544
    s_cmp_ge_u32 s60, s52
    s_cselect_b32 s61, s53, s61
    s_cselect_b32 s50, 40, s50
    s_cselect_b32 s51, 20, s51
    s_mul_i32 s60, s61, 1280
    s_lshl_b32 s63, s63, 8
    s_add_u32 s60, s60, s63
    s_mul_i32 s51, s51, 1280
    s_mul_i32 s50, s50, 1280
    s_add_u32 s61, s60, s51
    s_add_u32 s62, s60, s50
    s_add_u32 s63, s62, s51
    buffer_load_dword v32, v4, s[32:35], s60 offen offset:0
    buffer_load_dword v33, v4, s[32:35], s60 offen offset:1280
    buffer_load_dword v34, v4, s[32:35], s60 offen offset:2560
    buffer_load_dword v35, v4, s[32:35], s60 offen offset:3840
    buffer_load_dword v36, v4, s[32:35], s61 offen offset:0
    buffer_load_dword v37, v4, s[32:35], s61 offen offset:1280
    buffer_load_dword v38, v4, s[32:35], s61 offen offset:2560
    buffer_load_dword v39, v4, s[32:35], s61 offen offset:3840
    buffer_load_dword v40, v4, s[32:35], s62 offen offset:0
    buffer_load_dword v41, v4, s[32:35], s62 offen offset:1280
    buffer_load_dword v42, v4, s[32:35], s62 offen offset:2560
    buffer_load_dword v43, v4, s[32:35], s62 offen offset:3840
    buffer_load_dword v44, v4, s[32:35], s63 offen offset:0
    buffer_load_dword v45, v4, s[32:35], s63 offen offset:1280
    buffer_load_dword v46, v4, s[32:35], s63 offen offset:2560
    buffer_load_dword v47, v4, s[32:35], s63 offen offset:3840
    s_add_u32 s59, s58, 512
    s_min_u32 s59, s59, 679
    s_cmp_lt_u32 s59, 480
    s_cselect_b32 s32, s16, s8
    s_cselect_b32 s33, s17, s9
    s_mov_b32 s34, 819200
    s_cmov_b32 s34, 1966080
    s_cselect_b32 s60, 0, 480
    s_cselect_b32 s46, 96, 40
    s_mov_b32 s62, 0x6666667
    s_cmov_b32 s62, 0x2aaaaab
    s_cselect_b32 s67, 16, 20
    s_cselect_b32 s50, 8, 4
    s_cselect_b32 s51, 4, 8
    s_cselect_b32 s52, 1000, 32
    s_mov_b32 s43, 0x1198000
    s_cmov_b32 s43, 0x1180000
    s_sub_u32 s60, s59, s60
    s_mul_hi_u32 s63, s60, s62
    s_mul_i32 s61, s63, s46
    s_sub_u32 s60, s60, s61
    s_mul_i32 s48, s63, 544
    s_add_u32 s48, s48, s60
    s_lshl_b32 s48, s48, 10
    s_add_u32 s66, s48, s43
    s_mov_b32 s70, 139264
    s_mul_i32 s61, s60, s67
    s_mul_i32 s53, s60, 80
    s_sub_u32 s53, s53, 2544
    s_cmp_ge_u32 s60, s52
    s_cselect_b32 s61, s53, s61
    s_cselect_b32 s50, 40, s50
    s_cselect_b32 s51, 20, s51
    s_mul_i32 s60, s61, 1280
    s_lshl_b32 s63, s63, 8
    s_add_u32 s60, s60, s63
    s_mul_i32 s51, s51, 1280
    s_mul_i32 s50, s50, 1280
    s_add_u32 s61, s60, s51
    s_add_u32 s62, s60, s50
    s_add_u32 s63, s62, s51
    buffer_load_dword v48, v4, s[32:35], s60 offen offset:0
    buffer_load_dword v49, v4, s[32:35], s60 offen offset:1280
    buffer_load_dword v50, v4, s[32:35], s60 offen offset:2560
    buffer_load_dword v51, v4, s[32:35], s60 offen offset:3840
    buffer_load_dword v52, v4, s[32:35], s61 offen offset:0
    buffer_load_dword v53, v4, s[32:35], s61 offen offset:1280
    buffer_load_dword v54, v4, s[32:35], s61 offen offset:2560
    buffer_load_dword v55, v4, s[32:35], s61 offen offset:3840
    buffer_load_dword v56, v4, s[32:35], s62 offen offset:0
    buffer_load_dword v57, v4, s[32:35], s62 offen offset:1280
    buffer_load_dword v58, v4, s[32:35], s62 offen offset:2560
    buffer_load_dword v59, v4, s[32:35], s62 offen offset:3840
    buffer_load_dword v60, v4, s[32:35], s63 offen offset:0
    buffer_load_dword v61, v4, s[32:35], s63 offen offset:1280
    buffer_load_dword v62, v4, s[32:35], s63 offen offset:2560
    buffer_load_dword v63, v4, s[32:35], s63 offen offset:3840
    v_lshrrev_b32 v10, 3, v0
    v_and_b32 v11, 7, v0
    v_mul_u32_u24 v12, 160, v11
    v_mul_u32_u24 v13, 1280, v10
    v_add_u32 v13, v13, v12
    v_add_u32 v12, 40960, v12
    s_waitcnt vmcnt(48)
    s_barrier
    ds_read_b128 v[64:67], v13 offset:0
    ds_read_b128 v[104:107], v12 offset:0
    ds_read_b128 v[68:71], v13 offset:16
    ds_read_b128 v[108:111], v12 offset:16
    ds_read_b128 v[72:75], v13 offset:32
    ds_read_b128 v[112:115], v12 offset:32
    ds_read_b128 v[76:79], v13 offset:48
    ds_read_b128 v[116:119], v12 offset:48
    ds_read_b128 v[80:83], v13 offset:64
    ds_read_b128 v[120:123], v12 offset:64
    ds_read_b128 v[84:87], v13 offset:80
    ds_read_b128 v[124:127], v12 offset:80
    ds_read_b128 v[88:91], v13 offset:96
    ds_read_b128 v[128:131], v12 offset:96
    ds_read_b128 v[92:95], v13 offset:112
    ds_read_b128 v[132:135], v12 offset:112
    ds_read_b128 v[96:99], v13 offset:128
    ds_read_b128 v[136:139], v12 offset:128
    ds_read_b128 v[100:103], v13 offset:144
    ds_read_b128 v[140:143], v12 offset:144
    v_mov_b32 v144, 0
    v_mov_b32 v145, 0
    s_waitcnt lgkmcnt(0)
    v_dot2_f32_bf16 v144, v64, v104, v144
    v_dot2_f32_bf16 v145, v65, v105, v145
    v_dot2_f32_bf16 v144, v66, v106, v144
    v_dot2_f32_bf16 v145, v67, v107, v145
    v_dot2_f32_bf16 v144, v68, v108, v144
    v_dot2_f32_bf16 v145, v69, v109, v145
    v_dot2_f32_bf16 v144, v70, v110, v144
    v_dot2_f32_bf16 v145, v71, v111, v145
    v_dot2_f32_bf16 v144, v72, v112, v144
    v_dot2_f32_bf16 v145, v73, v113, v145
    v_dot2_f32_bf16 v144, v74, v114, v144
    v_dot2_f32_bf16 v145, v75, v115, v145
    v_dot2_f32_bf16 v144, v76, v116, v144
    v_dot2_f32_bf16 v145, v77, v117, v145
    v_dot2_f32_bf16 v144, v78, v118, v144
    v_dot2_f32_bf16 v145, v79, v119, v145
    v_dot2_f32_bf16 v144, v80, v120, v144
    v_dot2_f32_bf16 v145, v81, v121, v145
    v_dot2_f32_bf16 v144, v82, v122, v144
    v_dot2_f32_bf16 v145, v83, v123, v145
    v_dot2_f32_bf16 v144, v84, v124, v144
    v_dot2_f32_bf16 v145, v85, v125, v145
    v_dot2_f32_bf16 v144, v86, v126, v144
    v_dot2_f32_bf16 v145, v87, v127, v145
    v_dot2_f32_bf16 v144, v88, v128, v144
    v_dot2_f32_bf16 v145, v89, v129, v145
    v_dot2_f32_bf16 v144, v90, v130, v144
    v_dot2_f32_bf16 v145, v91, v131, v145
    v_dot2_f32_bf16 v144, v92, v132, v144
    v_dot2_f32_bf16 v145, v93, v133, v145
    v_dot2_f32_bf16 v144, v94, v134, v144
    v_dot2_f32_bf16 v145, v95, v135, v145
    v_dot2_f32_bf16 v144, v96, v136, v144
    v_dot2_f32_bf16 v145, v97, v137, v145
    v_dot2_f32_bf16 v144, v98, v138, v144
    v_dot2_f32_bf16 v145, v99, v139, v145
    v_dot2_f32_bf16 v144, v100, v140, v144
    v_dot2_f32_bf16 v145, v101, v141, v145
    v_dot2_f32_bf16 v144, v102, v142, v144
    v_dot2_f32_bf16 v145, v103, v143, v145
    s_nop 2
    v_add_f32 v144, v144, v145
    s_nop 1
    v_add_f32_dpp v144, v144, v144 quad_perm:[1,0,3,2] row_mask:0xf bank_mask:0xf
    s_nop 1
    v_add_f32_dpp v144, v144, v144 quad_perm:[2,3,0,1] row_mask:0xf bank_mask:0xf
    s_nop 1
    v_add_f32_dpp v144, v144, v144 row_half_mirror row_mask:0xf bank_mask:0xf
    v_cvt_pk_bf16_f32 v144, v144, v144
    v_and_b32 v144, 0xffff0000, v144
    v_mul_f32 v144, 0xbfb8aa3b, v144
    v_exp_f32 v144, v144
    s_nop 0
    v_add_f32 v144, 1.0, v144
    v_rcp_f32 v144, v144
    s_nop 0
    v_cvt_pk_bf16_f32 v144, v144, v144
    v_and_b32 v144, 0xffff0000, v144
    v_sub_f32 v145, 1.0, v144
    v_cvt_pk_bf16_f32 v145, v145, v145
    v_and_b32 v145, 0xffff0000, v145
    s_lshl_b32 s54, s47, 7
    s_add_u32 s54, s54, 0x1480000
    s_add_u32 s55, s54, 8192
    v_lshlrev_b32 v146, 2, v10
    v_cmp_ne_u32 vcc, 0, v11
    s_nop 1
    v_cndmask_b32 v146, v146, v147, vcc
    buffer_store_dword v144, v146, s[28:31], s54 offen sc1
    buffer_store_dword v145, v146, s[28:31], s55 offen sc1
    s_mov_b32 s52, 0x05040100
    s_mov_b32 s53, 0x07060302
    s_waitcnt vmcnt(2)
    s_mul_i32 s57, s36, 12288
    s_add_u32 s57, s57, 45056
    v_lshl_add_u32 v12, v6, 10, v5
    v_add_u32 v12, s57, v12
    v_add_u32 v13, s57, v3
    v_perm_b32 v64, v17, v16, s52
    v_perm_b32 v68, v17, v16, s53
    v_perm_b32 v65, v19, v18, s52
    v_perm_b32 v69, v19, v18, s53
    v_perm_b32 v66, v21, v20, s52
    v_perm_b32 v70, v21, v20, s53
    v_perm_b32 v67, v23, v22, s52
    v_perm_b32 v71, v23, v22, s53
    ds_write_b128 v12, v[64:67] offset:0
    ds_write_b128 v12, v[68:71] offset:16
    v_perm_b32 v72, v25, v24, s52
    v_perm_b32 v76, v25, v24, s53
    v_perm_b32 v73, v27, v26, s52
    v_perm_b32 v77, v27, v26, s53
    v_perm_b32 v74, v29, v28, s52
    v_perm_b32 v78, v29, v28, s53
    v_perm_b32 v75, v31, v30, s52
    v_perm_b32 v79, v31, v30, s53
    ds_write_b128 v12, v[72:75] offset:512
    ds_write_b128 v12, v[76:79] offset:528
    v_perm_b32 v80, v33, v32, s52
    v_perm_b32 v84, v33, v32, s53
    v_perm_b32 v81, v35, v34, s52
    v_perm_b32 v85, v35, v34, s53
    v_perm_b32 v82, v37, v36, s52
    v_perm_b32 v86, v37, v36, s53
    v_perm_b32 v83, v39, v38, s52
    v_perm_b32 v87, v39, v38, s53
    ds_write_b128 v12, v[80:83] offset:4096
    ds_write_b128 v12, v[84:87] offset:4112
    v_perm_b32 v88, v41, v40, s52
    v_perm_b32 v92, v41, v40, s53
    v_perm_b32 v89, v43, v42, s52
    v_perm_b32 v93, v43, v42, s53
    v_perm_b32 v90, v45, v44, s52
    v_perm_b32 v94, v45, v44, s53
    v_perm_b32 v91, v47, v46, s52
    v_perm_b32 v95, v47, v46, s53
    ds_write_b128 v12, v[88:91] offset:4608
    ds_write_b128 v12, v[92:95] offset:4624
    v_perm_b32 v96, v49, v48, s52
    v_perm_b32 v100, v49, v48, s53
    v_perm_b32 v97, v51, v50, s52
    v_perm_b32 v101, v51, v50, s53
    v_perm_b32 v98, v53, v52, s52
    v_perm_b32 v102, v53, v52, s53
    v_perm_b32 v99, v55, v54, s52
    v_perm_b32 v103, v55, v54, s53
    ds_write_b128 v12, v[96:99] offset:8192
    ds_write_b128 v12, v[100:103] offset:8208
    v_perm_b32 v104, v57, v56, s52
    v_perm_b32 v108, v57, v56, s53
    v_perm_b32 v105, v59, v58, s52
    v_perm_b32 v109, v59, v58, s53
    v_perm_b32 v106, v61, v60, s52
    v_perm_b32 v110, v61, v60, s53
    v_perm_b32 v107, v63, v62, s52
    v_perm_b32 v111, v63, v62, s53
    ds_write_b128 v12, v[104:107] offset:8704
    ds_write_b128 v12, v[108:111] offset:8720
    s_waitcnt lgkmcnt(0)
    ds_read_b128 v[16:19], v13 offset:0
    ds_read_b128 v[20:23], v13 offset:1024
    ds_read_b128 v[24:27], v13 offset:2048
    ds_read_b128 v[28:31], v13 offset:3072
    ds_read_b128 v[32:35], v13 offset:4096
    ds_read_b128 v[36:39], v13 offset:5120
    ds_read_b128 v[40:43], v13 offset:6144
    ds_read_b128 v[44:47], v13 offset:7168
    ds_read_b128 v[48:51], v13 offset:8192
    ds_read_b128 v[52:55], v13 offset:9216
    ds_read_b128 v[56:59], v13 offset:10240
    ds_read_b128 v[60:63], v13 offset:11264
    s_waitcnt lgkmcnt(8)
    buffer_store_dwordx4 v[16:19], v3, s[28:31], s64 offen sc1
    s_add_u32 s64, s64, s68
    buffer_store_dwordx4 v[20:23], v3, s[28:31], s64 offen sc1
    s_add_u32 s64, s64, s68
    buffer_store_dwordx4 v[24:27], v3, s[28:31], s64 offen sc1
    s_add_u32 s64, s64, s68
    buffer_store_dwordx4 v[28:31], v3, s[28:31], s64 offen sc1
    s_waitcnt lgkmcnt(4)
    buffer_store_dwordx4 v[32:35], v3, s[28:31], s65 offen sc1
    s_add_u32 s65, s65, s69
    buffer_store_dwordx4 v[36:39], v3, s[28:31], s65 offen sc1
    s_add_u32 s65, s65, s69
    buffer_store_dwordx4 v[40:43], v3, s[28:31], s65 offen sc1
    s_add_u32 s65, s65, s69
    buffer_store_dwordx4 v[44:47], v3, s[28:31], s65 offen sc1
    s_waitcnt lgkmcnt(0)
    buffer_store_dwordx4 v[48:51], v3, s[28:31], s66 offen sc1
    s_add_u32 s66, s66, s70
    buffer_store_dwordx4 v[52:55], v3, s[28:31], s66 offen sc1
    s_add_u32 s66, s66, s70
    buffer_store_dwordx4 v[56:59], v3, s[28:31], s66 offen sc1
    s_add_u32 s66, s66, s70
    buffer_store_dwordx4 v[60:63], v3, s[28:31], s66 offen sc1
    v_mov_b32 v14, 0
    v_mov_b32 v15, 1
    s_waitcnt vmcnt(0)
    s_barrier
    s_cmp_lg_u32 s36, 0
    s_cbranch_scc1 P1_AUX_NOADD0
    s_mov_b64 exec, 1
    global_atomic_add v14, v15, s[44:45] offset:0 sc1
    s_mov_b64 exec, -1
P1_AUX_NOADD0:
    s_mov_b32 s34, 1966080
    s_mov_b32 s32, s12
    s_mov_b32 s33, s13
    s_mov_b32 s60, s14
    s_mov_b32 s61, s15
    s_mov_b32 s62, 1966080
    s_mov_b32 s63, 0x00020000
    s_lshr_b32 s57, s40, 3
    s_lshl_b32 s57, s57, 2
    s_add_u32 s57, s57, s36
    s_mul_i32 s57, s57, 6144
    s_and_b32 s59, s39, 3
    s_mul_i32 s59, s59, 768
    s_add_u32 s57, s57, s59
    v_add_u32 v152, 0, v1
    v_mul_u32_u24 v153, 1366, v152
    v_lshrrev_b32 v153, 16, v153
    v_mul_u32_u24 v154, 48, v153
    v_sub_u32 v154, v152, v154
    v_and_b32 v155, 1, v153
    v_lshrrev_b32 v153, 1, v153
    v_lshl_add_u32 v153, v153, 6, v155
    v_mul_u32_u24 v153, 3072, v153
    v_lshl_add_u32 v156, v154, 4, v153
    buffer_load_dwordx4 a[120:123], v156, s[32:35], s57 offen
    buffer_load_dwordx4 a[180:183], v156, s[60:63], s57 offen
    v_add_u32 v152, 64, v1
    v_mul_u32_u24 v153, 1366, v152
    v_lshrrev_b32 v153, 16, v153
    v_mul_u32_u24 v154, 48, v153
    v_sub_u32 v154, v152, v154
    v_and_b32 v155, 1, v153
    v_lshrrev_b32 v153, 1, v153
    v_lshl_add_u32 v153, v153, 6, v155
    v_mul_u32_u24 v153, 3072, v153
    v_lshl_add_u32 v157, v154, 4, v153
    buffer_load_dwordx4 a[124:127], v157, s[32:35], s57 offen
    buffer_load_dwordx4 a[184:187], v157, s[60:63], s57 offen
    v_add_u32 v152, 128, v1
    v_mul_u32_u24 v153, 1366, v152
    v_lshrrev_b32 v153, 16, v153
    v_mul_u32_u24 v154, 48, v153
    v_sub_u32 v154, v152, v154
    v_and_b32 v155, 1, v153
    v_lshrrev_b32 v153, 1, v153
    v_lshl_add_u32 v153, v153, 6, v155
    v_mul_u32_u24 v153, 3072, v153
    v_lshl_add_u32 v158, v154, 4, v153
    buffer_load_dwordx4 a[128:131], v158, s[32:35], s57 offen
    buffer_load_dwordx4 a[188:191], v158, s[60:63], s57 offen
    v_add_u32 v152, 192, v1
    v_mul_u32_u24 v153, 1366, v152
    v_lshrrev_b32 v153, 16, v153
    v_mul_u32_u24 v154, 48, v153
    v_sub_u32 v154, v152, v154
    v_and_b32 v155, 1, v153
    v_lshrrev_b32 v153, 1, v153
    v_lshl_add_u32 v153, v153, 6, v155
    v_mul_u32_u24 v153, 3072, v153
    v_lshl_add_u32 v159, v154, 4, v153
    buffer_load_dwordx4 a[132:135], v159, s[32:35], s57 offen
    buffer_load_dwordx4 a[192:195], v159, s[60:63], s57 offen
    v_add_u32 v152, 256, v1
    v_mul_u32_u24 v153, 1366, v152
    v_lshrrev_b32 v153, 16, v153
    v_mul_u32_u24 v154, 48, v153
    v_sub_u32 v154, v152, v154
    v_and_b32 v155, 1, v153
    v_lshrrev_b32 v153, 1, v153
    v_lshl_add_u32 v153, v153, 6, v155
    v_mul_u32_u24 v153, 3072, v153
    v_lshl_add_u32 v160, v154, 4, v153
    buffer_load_dwordx4 a[136:139], v160, s[32:35], s57 offen
    buffer_load_dwordx4 a[196:199], v160, s[60:63], s57 offen
    v_add_u32 v152, 320, v1
    v_mul_u32_u24 v153, 1366, v152
    v_lshrrev_b32 v153, 16, v153
    v_mul_u32_u24 v154, 48, v153
    v_sub_u32 v154, v152, v154
    v_and_b32 v155, 1, v153
    v_lshrrev_b32 v153, 1, v153
    v_lshl_add_u32 v153, v153, 6, v155
    v_mul_u32_u24 v153, 3072, v153
    v_lshl_add_u32 v161, v154, 4, v153
    buffer_load_dwordx4 a[140:143], v161, s[32:35], s57 offen
    buffer_load_dwordx4 a[200:203], v161, s[60:63], s57 offen
    v_add_u32 v152, 384, v1
    v_mul_u32_u24 v153, 1366, v152
    v_lshrrev_b32 v153, 16, v153
    v_mul_u32_u24 v154, 48, v153
    v_sub_u32 v154, v152, v154
    v_and_b32 v155, 1, v153
    v_lshrrev_b32 v153, 1, v153
    v_lshl_add_u32 v153, v153, 6, v155
    v_mul_u32_u24 v153, 3072, v153
    v_lshl_add_u32 v162, v154, 4, v153
    buffer_load_dwordx4 a[144:147], v162, s[32:35], s57 offen
    buffer_load_dwordx4 a[204:207], v162, s[60:63], s57 offen
    v_add_u32 v152, 448, v1
    v_mul_u32_u24 v153, 1366, v152
    v_lshrrev_b32 v153, 16, v153
    v_mul_u32_u24 v154, 48, v153
    v_sub_u32 v154, v152, v154
    v_and_b32 v155, 1, v153
    v_lshrrev_b32 v153, 1, v153
    v_lshl_add_u32 v153, v153, 6, v155
    v_mul_u32_u24 v153, 3072, v153
    v_lshl_add_u32 v163, v154, 4, v153
    buffer_load_dwordx4 a[148:151], v163, s[32:35], s57 offen
    buffer_load_dwordx4 a[208:211], v163, s[60:63], s57 offen
    v_add_u32 v152, 512, v1
    v_mul_u32_u24 v153, 1366, v152
    v_lshrrev_b32 v153, 16, v153
    v_mul_u32_u24 v154, 48, v153
    v_sub_u32 v154, v152, v154
    v_and_b32 v155, 1, v153
    v_lshrrev_b32 v153, 1, v153
    v_lshl_add_u32 v153, v153, 6, v155
    v_mul_u32_u24 v153, 3072, v153
    v_lshl_add_u32 v164, v154, 4, v153
    buffer_load_dwordx4 a[152:155], v164, s[32:35], s57 offen
    buffer_load_dwordx4 a[212:215], v164, s[60:63], s57 offen
    v_add_u32 v152, 576, v1
    v_mul_u32_u24 v153, 1366, v152
    v_lshrrev_b32 v153, 16, v153
    v_mul_u32_u24 v154, 48, v153
    v_sub_u32 v154, v152, v154
    v_and_b32 v155, 1, v153
    v_lshrrev_b32 v153, 1, v153
    v_lshl_add_u32 v153, v153, 6, v155
    v_mul_u32_u24 v153, 3072, v153
    v_lshl_add_u32 v165, v154, 4, v153
    buffer_load_dwordx4 a[156:159], v165, s[32:35], s57 offen
    buffer_load_dwordx4 a[216:219], v165, s[60:63], s57 offen
    v_add_u32 v152, 640, v1
    v_mul_u32_u24 v153, 1366, v152
    v_lshrrev_b32 v153, 16, v153
    v_mul_u32_u24 v154, 48, v153
    v_sub_u32 v154, v152, v154
    v_and_b32 v155, 1, v153
    v_lshrrev_b32 v153, 1, v153
    v_lshl_add_u32 v153, v153, 6, v155
    v_mul_u32_u24 v153, 3072, v153
    v_lshl_add_u32 v166, v154, 4, v153
    buffer_load_dwordx4 a[160:163], v166, s[32:35], s57 offen
    buffer_load_dwordx4 a[220:223], v166, s[60:63], s57 offen
    v_add_u32 v152, 704, v1
    v_mul_u32_u24 v153, 1366, v152
    v_lshrrev_b32 v153, 16, v153
    v_mul_u32_u24 v154, 48, v153
    v_sub_u32 v154, v152, v154
    v_and_b32 v155, 1, v153
    v_lshrrev_b32 v153, 1, v153
    v_lshl_add_u32 v153, v153, 6, v155
    v_mul_u32_u24 v153, 3072, v153
    v_lshl_add_u32 v167, v154, 4, v153
    buffer_load_dwordx4 a[164:167], v167, s[32:35], s57 offen
    buffer_load_dwordx4 a[224:227], v167, s[60:63], s57 offen
    v_add_u32 v152, 768, v1
    v_mul_u32_u24 v153, 1366, v152
    v_lshrrev_b32 v153, 16, v153
    v_mul_u32_u24 v154, 48, v153
    v_sub_u32 v154, v152, v154
    v_and_b32 v155, 1, v153
    v_lshrrev_b32 v153, 1, v153
    v_lshl_add_u32 v153, v153, 6, v155
    v_mul_u32_u24 v153, 3072, v153
    v_lshl_add_u32 v168, v154, 4, v153
    buffer_load_dwordx4 a[168:171], v168, s[32:35], s57 offen
    buffer_load_dwordx4 a[228:231], v168, s[60:63], s57 offen
    v_add_u32 v152, 832, v1
    v_mul_u32_u24 v153, 1366, v152
    v_lshrrev_b32 v153, 16, v153
    v_mul_u32_u24 v154, 48, v153
    v_sub_u32 v154, v152, v154
    v_and_b32 v155, 1, v153
    v_lshrrev_b32 v153, 1, v153
    v_lshl_add_u32 v153, v153, 6, v155
    v_mul_u32_u24 v153, 3072, v153
    v_lshl_add_u32 v169, v154, 4, v153
    buffer_load_dwordx4 a[172:175], v169, s[32:35], s57 offen
    buffer_load_dwordx4 a[232:235], v169, s[60:63], s57 offen
    v_add_u32 v152, 896, v1
    v_mul_u32_u24 v153, 1366, v152
    v_lshrrev_b32 v153, 16, v153
    v_mul_u32_u24 v154, 48, v153
    v_sub_u32 v154, v152, v154
    v_and_b32 v155, 1, v153
    v_lshrrev_b32 v153, 1, v153
    v_lshl_add_u32 v153, v153, 6, v155
    v_mul_u32_u24 v153, 3072, v153
    v_lshl_add_u32 v170, v154, 4, v153
    buffer_load_dwordx4 a[176:179], v170, s[32:35], s57 offen
    buffer_load_dwordx4 a[236:239], v170, s[60:63], s57 offen
    s_mov_b32 s32, s44
    s_mov_b32 s33, s45
    v_mov_b32 v128, 0
    global_load_dword v147, v128, s[32:33] sc1
    v_and_b32 v130, 31, v1
    v_mul_u32_u24 v249, 0x7f0000, v2
    v_lshlrev_b32 v249, 8, v249
    v_lshl_add_u32 v249, v130, 2, v249
    v_lshrrev_b32 v29, 1, v130
    v_and_b32 v29, 7, v29
    v_xor_b32 v29, v29, v2
    s_and_b32 s3, s36, 1
    s_lshl_b32 s3, s3, 13
    s_add_u32 s3, s3, 110592
    v_lshlrev_b32 v30, 7, v130
    v_add_u32 v30, s3, v30
    v_xor_b32 v31, 0, v29
    v_lshl_add_u32 v142, v31, 4, v30
    v_xor_b32 v31, 2, v29
    v_lshl_add_u32 v143, v31, 4, v30
    v_xor_b32 v31, 4, v29
    v_lshl_add_u32 v144, v31, 4, v30
    v_xor_b32 v31, 6, v29
    v_lshl_add_u32 v145, v31, 4, v30
    v_lshrrev_b32 v31, 2, v1
    v_and_b32 v31, 3, v31
    v_lshl_add_u32 v31, v2, 3, v31
    v_mul_u32_u24 v31, 192, v31
    v_lshrrev_b32 v29, 4, v1
    v_and_b32 v29, 1, v29
    v_mul_u32_u24 v29, 12320, v29
    v_add_u32 v31, v31, v29
    v_and_b32 v29, 1, v1
    v_lshl_add_u32 v31, v29, 4, v31
    v_and_b32 v29, 2, v1
    v_lshl_add_u32 v31, v29, 2, v31
    s_lshr_b32 s3, s36, 1
    s_mul_i32 s3, s3, 96
    s_add_u32 s3, s3, 126976
    v_add_u32 v146, s3, v31
    s_and_b32 s3, s2, 1
    s_lshl_b32 s3, s3, 2
    s_lshr_b32 s34, s2, 6
    s_add_u32 s3, s3, s34
    s_mul_i32 s3, s3, 5
    s_lshr_b32 s34, s3, 1
    s_mul_i32 s34, s34, 139264
    s_and_b32 s3, s3, 1
    s_lshl_b32 s35, s3, 8
    s_add_u32 s34, s34, s35
    s_mul_i32 s35, s36, 24576
    s_add_u32 s34, s34, s35
    s_add_u32 s34, s34, 0x1180000
    s_mul_i32 s3, s3, 138752
    s_add_u32 s3, s3, 256
    v_and_b32 v29, 15, v1
    v_lshlrev_b32 v29, 4, v29
    v_lshrrev_b32 v30, 4, v1
    v_lshl_add_u32 v29, v30, 9, v29
    v_add_u32 v244, s34, v29
    v_add_u32 v245, s3, v244
    v_add_u32 v246, 139264, v244
    v_add_u32 v247, 139264, v245
    v_add_u32 v248, 278528, v244
    v_pk_mov_b32 v[32:33], 0, 0
    v_pk_mov_b32 v[34:35], 0, 0
    s_nop 1
    v_mfma_f32_32x32x16_bf16 a[0:15], v[32:35], v[32:35], 0
    v_mfma_f32_32x32x16_bf16 a[16:31], v[32:35], v[32:35], 0
    v_mfma_f32_32x32x16_bf16 a[32:47], v[32:35], v[32:35], 0
    v_mfma_f32_32x32x16_bf16 a[48:63], v[32:35], v[32:35], 0
    v_lshrrev_b32 v29, 3, v1
    s_lshl_b32 s3, s36, 5
    v_add_u32 v29, s3, v29
    v_mul_u32_u24 v29, 1280, v29
    v_and_b32 v30, 7, v1
    v_lshrrev_b32 v31, 4, v1
    v_xor_b32 v30, v30, v31
    v_lshl_add_u32 v132, v30, 4, v29
    v_xor_b32 v29, 64, v132
    v_add_u32 v133, 9216, v29
    v_add_u32 v134, 18432, v132
    v_add_u32 v135, 27648, v29
    s_and_b32 s3, s36, 1
    s_mul_i32 s3, s3, 384
    v_add_u32 v29, s3, v1
    v_mul_u32_u24 v30, 5462, v29
    v_lshrrev_b32 v30, 16, v30
    v_mul_u32_u24 v31, 12, v30
    v_sub_u32 v31, v29, v31
    v_mul_u32_u24 v30, 3072, v30
    v_lshl_add_u32 v136, v31, 4, v30
    v_cmp_lt_u32 vcc, 7, v31
    v_mov_b32 v29, 14400
    v_mov_b32 v30, 17280
    v_cndmask_b32 v29, v29, v30, vcc
    v_add_u32 v137, v136, v29
    v_cmp_lt_u32 vcc, 3, v31
    v_mov_b32 v29, 28800
    v_mov_b32 v30, 31680
    v_cndmask_b32 v29, v29, v30, vcc
    v_add_u32 v138, v136, v29
    v_add_u32 v139, 46080, v136
    v_add_u32 v140, 50176, v137
    v_add_u32 v141, 50176, v138
    s_lshr_b32 s72, s2, 3
    s_and_b32 s73, s72, 7
    s_lshr_b32 s74, s72, 3
    s_mul_i32 s75, s73, 5
    s_mul_i32 s76, s74, 10
    s_add_u32 s75, s75, s76
    s_lshr_b32 s75, s75, 2
    s_cmp_ge_u32 s75, 10
    s_cselect_b32 s76, 10, 0
    s_sub_u32 s75, s75, s76
    s_and_b32 s76, s2, 4
    s_lshl_b32 s76, s76, 1
    s_add_u32 s73, s73, s76
    s_mul_i32 s73, s73, 163840
    s_lshl_b32 s76, s75, 7
    s_add_u32 s3, s73, s76
    s_and_b32 s76, s2, 3
    s_lshl_b32 s76, s76, 2
    s_add_u32 s74, s74, s76
    s_mul_i32 s74, s74, 192
    s_mul_i32 s78, s75, 196608
    s_add_u32 s78, s74, s78
    s_mov_b32 s74, s3
    s_mov_b32 s3, s75
    s_cmp_lt_u32 s36, 2
    s_cselect_b32 s76, s12, s14
    s_cselect_b32 s77, s13, s15
    s_add_u32 s76, s76, s78
    s_addc_u32 s77, s77, 0
    s_mov_b32 s78, 1966080
    s_mov_b32 s79, 0x00020000
    s_add_u32 s72, s4, s74
    s_addc_u32 s73, s5, 0
    s_mov_b32 s74, 2621440
    s_mov_b32 s75, 0x00020000
P2_SETUP:
    s_and_b32 s6, s2, 7
    s_lshr_b32 s7, s2, 3
    s_and_b32 s37, s6, 3
    s_lshl_b32 s37, s37, 3
    s_lshr_b32 s9, s7, 2
    s_add_u32 s37, s37, s9
    s_lshr_b32 s38, s6, 2
    s_lshl_b32 s38, s38, 2
    s_and_b32 s52, s7, 3
    s_add_u32 s38, s38, s52
    s_lshl_b32 s38, s38, 3
    s_and_b32 s8, s36, 1
    s_lshl_b32 s9, s8, 2
    s_add_u32 s38, s38, s9
    s_and_b32 s9, s36, 2
    s_add_u32 s39, s38, s9
    s_xor_b32 s9, s9, 2
    s_add_u32 s34, s38, s9
    s_lshr_b32 s35, s36, 1
    v_lshrrev_b32 v2, 5, v1
    v_lshlrev_b32 v3, 4, v1
    v_and_b32 v6, 31, v1
    v_lshlrev_b32 v7, 3, v6
    s_mul_i32 s26, s37, 81920
    s_mul_i32 s17, s35, 40960
    s_add_u32 s19, s26, s17
    s_add_u32 s19, s19, 0x280000
    s_mul_i32 s20, s39, 1280
    s_add_u32 s20, s20, s26
    s_mul_i32 s21, s34, 1280
    s_add_u32 s21, s21, s26
    s_mul_i32 s52, s52, 0
    s_lshr_b32 s52, s52, 1
    s_lshr_b32 s24, s6, 2
    s_lshl_b32 s24, s24, 3
    s_and_b32 s9, s7, 7
    s_add_u32 s24, s24, s9
    s_and_b32 s25, s6, 3
    s_lshl_b32 s25, s25, 2
    s_lshr_b32 s16, s7, 3
    s_add_u32 s25, s25, s16
    s_mul_i32 s9, s9, 5
    s_mul_i32 s16, s16, 10
    s_add_u32 s9, s9, s16
    s_lshr_b32 s9, s9, 2
    s_cmp_ge_u32 s9, 10
    s_cselect_b32 s16, 10, 0
    s_sub_u32 s60, s9, s16
    s_lshl_b32 s23, s39, 7
    s_add_u32 s23, s23, 0x1480000
    s_lshl_b32 s61, s36, 12
    s_add_u32 s61, s61, 28544
    s_mul_i32 s62, s35, 12320
    s_mul_i32 s9, s8, 6144
    s_add_u32 s62, s62, s9
    s_add_u32 s62, s62, 44928
    s_add_u32 s63, s62, 4096
    s_mov_b32 s66, 0xfffffb80
    s_movk_i32 s67, 128
    s_mov_b32 s68, 0xffe50000
    s_mov_b32 s69, 196608
    s_mov_b32 s58, 0
    s_mov_b32 s57, 82048
    s_mov_b32 s71, 0xfffebf80
    s_mov_b32 s48, 41024
    s_mov_b32 s54, 0xffff7900
    s_movk_i32 s55, 3840
    s_waitcnt vmcnt(0)
    v_cmp_gt_u32 vcc, 64, v147
    s_nop 1
    s_cbranch_vccz SYNC0_DONE
    s_cmp_lg_u32 s36, 0
    s_cbranch_scc1 SYNC0_DONE
    s_mov_b32 s3, 1048576
SYNC0_SPIN:
    global_load_dword v147, v128, s[32:33] sc1
    s_waitcnt vmcnt(0)
    v_cmp_gt_u32 vcc, 64, v147
    s_sub_u32 s3, s3, 1
    s_cbranch_scc1 SYNC0_DONE
    s_cbranch_vccz SYNC0_DONE
    s_sleep 1
    s_branch SYNC0_SPIN
SYNC0_DONE:
    s_lshl_b32 s3, s2, 7
    s_add_u32 s3, s3, 0x1490000
    v_lshlrev_b32 v40, 4, v0
    v_mov_b32 v42, 1
    v_mov_b32 v43, 1
    v_mov_b32 v44, 1
    v_mov_b32 v45, 1
    s_waitcnt vmcnt(0)
    s_barrier
    s_cmp_lg_u32 s36, 0
    s_cbranch_scc1 P2_NOFLAG
    s_mov_b64 exec, 0xff
    buffer_store_dwordx4 v[42:45], v40, s[28:31], s3 offen sc1
    s_mov_b64 exec, -1
P2_NOFLAG:
    s_mov_b32 s14, s32
    s_mov_b32 s15, s33
    s_mov_b32 s33, s39
    s_lshl_b32 s3, s36, 12
    s_add_u32 m0, s3, 110592
    s_lshr_b32 s3, s36, 1
    buffer_load_dwordx4 v132, s[72:75], 0 offen offset:0 lds
    buffer_load_dwordx4 v133, s[72:75], 0 offen offset:1024 lds
    buffer_load_dwordx4 v134, s[72:75], 0 offen offset:2048 lds
    buffer_load_dwordx4 v135, s[72:75], 0 offen offset:3072 lds
    s_mul_i32 s3, s3, 32
    s_add_u32 m0, s3, 126976
    s_mul_i32 s3, s36, 6144
    s_add_u32 m0, m0, s3
    s_nop 0
    buffer_load_dwordx4 v136, s[76:79], 0 offen offset:0 lds
    buffer_load_dwordx4 v137, s[76:79], 0 offen offset:1024 lds
    buffer_load_dwordx4 v138, s[76:79], 0 offen offset:2048 lds
    buffer_load_dwordx4 v139, s[76:79], 0 offen offset:3072 lds
    s_add_u32 m0, m0, 4096
    s_nop 0
    buffer_load_dwordx4 v140, s[76:79], 0 offen offset:0 lds
    buffer_load_dwordx4 v141, s[76:79], 0 offen offset:1024 lds
    s_add_u32 s60, s60, 1
    s_cmp_eq_u32 s60, 10
    s_cselect_b32 s60, 0, s60
    s_cselect_b32 s64, s66, s67
    s_cselect_b32 s65, s68, s69
    s_cselect_b32 s70, -1, 0
    s_add_u32 s72, s72, s64
    s_addc_u32 s73, s73, s70
    s_add_u32 s76, s76, s65
    s_addc_u32 s77, s77, s70
    s_add_u32 m0, s58, s61
    s_nop 0
    buffer_load_dwordx4 v132, s[72:75], 0 offen offset:0 lds
    buffer_load_dwordx4 v133, s[72:75], 0 offen offset:1024 lds
    buffer_load_dwordx4 v134, s[72:75], 0 offen offset:2048 lds
    buffer_load_dwordx4 v135, s[72:75], 0 offen offset:3072 lds
    s_add_u32 m0, s58, s62
    s_nop 0
    buffer_load_dwordx4 v136, s[76:79], 0 offen offset:0 lds
    buffer_load_dwordx4 v137, s[76:79], 0 offen offset:1024 lds
    buffer_load_dwordx4 v138, s[76:79], 0 offen offset:2048 lds
    buffer_load_dwordx4 v139, s[76:79], 0 offen offset:3072 lds
    s_add_u32 m0, s58, s63
    s_nop 0
    buffer_load_dwordx4 v140, s[76:79], 0 offen offset:0 lds
    buffer_load_dwordx4 v141, s[76:79], 0 offen offset:1024 lds
    s_add_u32 s60, s60, 1
    s_cmp_eq_u32 s60, 10
    s_cselect_b32 s60, 0, s60
    s_cselect_b32 s64, s66, s67
    s_cselect_b32 s65, s68, s69
    s_cselect_b32 s70, -1, 0
    s_add_u32 s72, s72, s64
    s_addc_u32 s73, s73, s70
    s_add_u32 s76, s76, s65
    s_addc_u32 s77, s77, s70
    s_mov_b32 s58, 41024
    s_and_b32 s9, s6, 3
    v_min_u32 v16, 47, v1
    v_lshrrev_b32 v17, 4, v16
    v_and_b32 v18, 7, v16
    v_lshl_add_u32 v17, v17, 3, v18
    v_lshrrev_b32 v18, 3, v16
    v_and_b32 v18, 1, v18
    v_lshlrev_b32 v18, 2, v18
    v_lshl_add_u32 v16, v17, 3, v18
    v_add_u32 v16, s9, v16
    v_lshlrev_b32 v16, 7, v16
    v_mov_b32 v10, 1
    s_mul_i32 s22, s52, 3840
    s_add_u32 s16, s26, 8192
    s_add_u32 s18, s16, s17
    s_mov_b32 s27, 0x1490000
    v_lshlrev_b32 v11, 4, v6
    v_lshl_add_u32 v4, v2, 8, v11
    v_lshl_add_u32 v5, v2, 6, v11
    v_add_u32 v5, 256, v5
    v_cmp_gt_u32 vcc, 16, v6
    s_add_u32 s18, s18, 40960
    s_nop 0
    v_cndmask_b32 v4, v5, v4, vcc
    v_add_u32 v9, s16, v4
    v_add_u32 v4, s17, v9
    v_mov_b32 v5, 0x7f000000
    v_cmp_gt_u32 vcc, 20, v6
    v_add_u32 v106, s22, v3
    v_add_u32 v107, s22, v7
    v_cndmask_b32 v4, v5, v4, vcc
    v_cndmask_b32 v9, v5, v9, vcc
    v_cndmask_b32 v5, 0, 1, vcc
    v_cmp_eq_u32 vcc, 20, v6
    v_lshlrev_b32 v13, 2, v6
    s_nop 0
    v_cndmask_b32 v4, v4, 0, vcc
    v_cndmask_b32 v9, v9, 0, vcc
    v_mad_u32_u24 v4, v5, s22, v4
    s_add_u32 s40, s10, s19
    s_addc_u32 s41, s11, 0
    s_mov_b32 s42, 40960
    s_mov_b32 s43, 0x00020000
    s_add_u32 s44, s10, 0x50e000
    s_addc_u32 s45, s11, 0
    s_mov_b32 s46, s18
    s_mov_b32 s47, 0x00020000
    s_lshl_b32 s9, s7, 1
    s_add_u32 s9, s9, s35
    s_lshr_b32 s16, s9, 4
    s_mul_i32 s16, s16, 393216
    s_and_b32 s9, s9, 15
    s_mul_i32 s9, s9, 192
    s_add_u32 s16, s16, s9
    s_and_b32 s9, s6, 1
    s_mul_i32 s9, s9, 1392640
    s_add_u32 s16, s16, s9
    s_add_u32 s16, s16, 0x1180000
    s_add_u32 s18, s10, s16
    s_addc_u32 s19, s11, 0
    s_mul_i32 s9, s36, 6144
    s_add_u32 s9, s9, 0
    v_add_u32 v11, s9, v3
    s_xor_b32 s9, s36, 2
    s_mul_i32 s9, s9, 6144
    s_add_u32 s9, s9, 0
    v_add_u32 v12, s9, v3
    v_pk_mov_b32 v[80:81], 0, 0
    v_pk_mov_b32 v[82:83], 0, 0
    v_pk_mov_b32 v[84:85], 0, 0
    v_pk_mov_b32 v[86:87], 0, 0
    v_pk_mov_b32 v[124:125], 0, 0
    v_pk_mov_b32 v[126:127], 0, 0
    v_pk_mov_b32 v[128:129], 0, 0
    v_pk_mov_b32 v[130:131], 0, 0
    s_lshl_b32 s9, s24, 9
    s_lshl_b32 s12, s8, 8
    s_add_u32 s12, s9, s12
    s_add_u32 s12, s12, 0x1482000
    s_mov_b32 s5, 0
    buffer_load_dword v250, v13, s[28:31], s12 offen sc1
    buffer_load_dword v251, v13, s[28:31], s12 offen offset:128 sc1
    buffer_load_dword v14, v13, s[28:31], s23 offen sc1
    buffer_load_dword v15, v13, s[28:31], s23 offen offset:128 sc1
    s_waitcnt vmcnt(14)
    s_barrier
    ds_read_b128 a[64:67], v142
    ds_read_b128 a[68:71], v142 offset:4096
    ds_read_b64_tr_b16 a[80:81], v146 offset:0
    ds_read_b64_tr_b16 a[82:83], v146 offset:768
    ds_read_b64_tr_b16 a[84:85], v146 offset:32
    ds_read_b64_tr_b16 a[86:87], v146 offset:800
    ds_read_b64_tr_b16 a[88:89], v146 offset:64
    ds_read_b64_tr_b16 a[90:91], v146 offset:832
    buffer_load_dword v17, v16, s[28:31], s27 offen sc1
    s_waitcnt lgkmcnt(0)
    v_mfma_f32_32x32x16_bf16 v[148:163], a[80:83], a[64:67], 0
    ds_read_b128 a[72:75], v143
    ds_read_b128 a[76:79], v143 offset:4096
    s_add_u32 m0, s58, s61
    s_nop 0
    buffer_load_dwordx4 v132, s[72:75], 0 offen offset:0 lds
    v_mfma_f32_32x32x16_bf16 v[196:211], a[80:83], a[68:71], 0
    ds_read_b64_tr_b16 a[92:93], v146 offset:3072
    ds_read_b64_tr_b16 a[94:95], v146 offset:3840
    buffer_load_dwordx4 v133, s[72:75], 0 offen offset:1024 lds
    v_mfma_f32_32x32x16_bf16 v[164:179], a[84:87], a[64:67], 0
    ds_read_b64_tr_b16 a[96:97], v146 offset:3104
    ds_read_b64_tr_b16 a[98:99], v146 offset:3872
    buffer_load_dwordx4 v134, s[72:75], 0 offen offset:2048 lds
    v_mfma_f32_32x32x16_bf16 v[212:227], a[84:87], a[68:71], 0
    ds_read_b64_tr_b16 a[100:101], v146 offset:3136
    ds_read_b64_tr_b16 a[102:103], v146 offset:3904
    buffer_load_dwordx4 v135, s[72:75], 0 offen offset:3072 lds
    v_mfma_f32_32x32x16_bf16 v[180:195], a[88:91], a[64:67], 0
    s_add_u32 m0, s58, s62
    s_nop 0
    buffer_load_dwordx4 v136, s[76:79], 0 offen offset:0 lds
    v_mfma_f32_32x32x16_bf16 v[228:243], a[88:91], a[68:71], 0
    buffer_load_dwordx4 v137, s[76:79], 0 offen offset:1024 lds
    s_waitcnt lgkmcnt(0)
    v_mfma_f32_32x32x16_bf16 v[148:163], a[92:95], a[72:75], v[148:163]
    ds_read_b128 a[64:67], v144
    ds_read_b128 a[68:71], v144 offset:4096
    buffer_load_dwordx4 v138, s[76:79], 0 offen offset:2048 lds
    v_mfma_f32_32x32x16_bf16 v[196:211], a[92:95], a[76:79], v[196:211]
    ds_read_b64_tr_b16 a[80:81], v146 offset:6144
    ds_read_b64_tr_b16 a[82:83], v146 offset:6912
    buffer_load_dwordx4 v139, s[76:79], 0 offen offset:3072 lds
    v_mfma_f32_32x32x16_bf16 v[164:179], a[96:99], a[72:75], v[164:179]
    ds_read_b64_tr_b16 a[84:85], v146 offset:6176
    ds_read_b64_tr_b16 a[86:87], v146 offset:6944
    s_add_u32 m0, s58, s63
    s_nop 0
    buffer_load_dwordx4 v140, s[76:79], 0 offen offset:0 lds
    v_mfma_f32_32x32x16_bf16 v[212:227], a[96:99], a[76:79], v[212:227]
    ds_read_b64_tr_b16 a[88:89], v146 offset:6208
    ds_read_b64_tr_b16 a[90:91], v146 offset:6976
    buffer_load_dwordx4 v141, s[76:79], 0 offen offset:1024 lds
    v_mfma_f32_32x32x16_bf16 v[180:195], a[100:103], a[72:75], v[180:195]
    v_mfma_f32_32x32x16_bf16 v[228:243], a[100:103], a[76:79], v[228:243]
    s_waitcnt lgkmcnt(0)
    v_mfma_f32_32x32x16_bf16 v[148:163], a[80:83], a[64:67], v[148:163]
    ds_read_b128 a[72:75], v145
    ds_read_b128 a[76:79], v145 offset:4096
    v_mfma_f32_32x32x16_bf16 v[196:211], a[80:83], a[68:71], v[196:211]
    ds_read_b64_tr_b16 a[92:93], v146 offset:9216
    ds_read_b64_tr_b16 a[94:95], v146 offset:9984
    v_mfma_f32_32x32x16_bf16 v[164:179], a[84:87], a[64:67], v[164:179]
    ds_read_b64_tr_b16 a[96:97], v146 offset:9248
    ds_read_b64_tr_b16 a[98:99], v146 offset:10016
    v_mfma_f32_32x32x16_bf16 v[212:227], a[84:87], a[68:71], v[212:227]
    ds_read_b64_tr_b16 a[100:101], v146 offset:9280
    ds_read_b64_tr_b16 a[102:103], v146 offset:10048
    v_mfma_f32_32x32x16_bf16 v[180:195], a[88:91], a[64:67], v[180:195]
    v_mfma_f32_32x32x16_bf16 v[228:243], a[88:91], a[68:71], v[228:243]
    s_waitcnt lgkmcnt(0)
    v_mfma_f32_32x32x16_bf16 v[148:163], a[92:95], a[72:75], v[148:163]
    v_mfma_f32_32x32x16_bf16 v[196:211], a[92:95], a[76:79], v[196:211]
    v_mfma_f32_32x32x16_bf16 v[164:179], a[96:99], a[72:75], v[164:179]
    v_mfma_f32_32x32x16_bf16 v[212:227], a[96:99], a[76:79], v[212:227]
    v_mfma_f32_32x32x16_bf16 v[180:195], a[100:103], a[72:75], v[180:195]
    v_mfma_f32_32x32x16_bf16 v[228:243], a[100:103], a[76:79], v[228:243]
    s_add_u32 s60, s60, 1
    s_cmp_eq_u32 s60, 10
    s_cselect_b32 s60, 0, s60
    s_cselect_b32 s64, s66, s67
    s_cselect_b32 s65, s68, s69
    s_cselect_b32 s70, -1, 0
    s_add_u32 s72, s72, s64
    s_addc_u32 s73, s73, s70
    s_add_u32 s76, s76, s65
    s_addc_u32 s77, s77, s70
    s_mov_b32 s58, 82048
    s_mov_b32 s57, 0
    v_add_u32 v142, s71, v142
    v_add_u32 v143, s71, v143
    v_add_u32 v144, s71, v144
    v_add_u32 v145, s71, v145
    v_add_u32 v146, s71, v146
    s_barrier
    s_add_u32 m0, s58, s61
    s_nop 0
    buffer_load_dwordx4 v132, s[72:75], 0 offen offset:0 lds
    buffer_load_dwordx4 v133, s[72:75], 0 offen offset:1024 lds
    buffer_load_dwordx4 v134, s[72:75], 0 offen offset:2048 lds
    buffer_load_dwordx4 v135, s[72:75], 0 offen offset:3072 lds
    s_add_u32 m0, s58, s62
    s_nop 0
    buffer_load_dwordx4 v136, s[76:79], 0 offen offset:0 lds
    buffer_load_dwordx4 v137, s[76:79], 0 offen offset:1024 lds
    buffer_load_dwordx4 v138, s[76:79], 0 offen offset:2048 lds
    buffer_load_dwordx4 v139, s[76:79], 0 offen offset:3072 lds
    s_add_u32 m0, s58, s63
    s_nop 0
    buffer_load_dwordx4 v140, s[76:79], 0 offen offset:0 lds
    buffer_load_dwordx4 v141, s[76:79], 0 offen offset:1024 lds
    s_add_u32 s60, s60, 1
    s_cmp_eq_u32 s60, 10
    s_cselect_b32 s60, 0, s60
    s_cselect_b32 s64, s66, s67
    s_cselect_b32 s65, s68, s69
    s_cselect_b32 s70, -1, 0
    s_add_u32 s72, s72, s64
    s_addc_u32 s73, s73, s70
    s_add_u32 s76, s76, s65
    s_addc_u32 s77, s77, s70
    s_waitcnt vmcnt(20)
    v_cmp_ne_u32 vcc, 1, v17
    s_nop 1
    s_cbranch_vccz SYNC1_DONE
SYNC1_AGAIN:
    s_cmp_lg_u32 s36, 0
    s_cbranch_scc1 SYNC1_DONE
    s_mov_b32 s3, 1048576
SYNC1_SPIN:
    buffer_load_dword v17, v16, s[28:31], s27 offen sc1
    s_waitcnt vmcnt(0)
    v_cmp_ne_u32 vcc, 1, v17
    s_sub_u32 s3, s3, 1
    s_cbranch_scc1 SYNC1_DONE
    s_cbranch_vccz SYNC1_DONE
    s_sleep 1
    s_branch SYNC1_SPIN
SYNC1_DONE:
    s_waitcnt vmcnt(20)
    s_barrier
    buffer_load_dwordx4 v[16:19], v3, s[28:31], s20 offen sc1
    buffer_load_dwordx2 v[40:41], v7, s[28:31], s20 offen offset:1024 sc1
    buffer_load_dwordx4 v[88:91], v106, s[40:43], 0 offen offset:0
    buffer_load_dwordx2 v[100:101], v107, s[40:43], 0 offen offset:1024
    buffer_load_dwordx4 v[20:23], v3, s[28:31], s20 offen offset:1280 sc1
    buffer_load_dwordx2 v[42:43], v7, s[28:31], s20 offen offset:2304 sc1
    buffer_load_dwordx4 v[24:27], v3, s[28:31], s21 offen sc1
    buffer_load_dwordx2 v[44:45], v7, s[28:31], s21 offen offset:1024 sc1
    buffer_load_dwordx4 v[28:31], v3, s[28:31], s21 offen offset:1280 sc1
    buffer_load_dwordx2 v[46:47], v7, s[28:31], s21 offen offset:2304 sc1
    buffer_load_dwordx4 v[108:111], v4, s[44:47], 0 offen offset:0
    buffer_load_dwordx4 v[112:115], v4, s[44:47], 0 offen offset:640
    buffer_load_dwordx4 v[92:95], v106, s[40:43], 0 offen offset:1280
    buffer_load_dwordx2 v[102:103], v107, s[40:43], 0 offen offset:2304
    buffer_load_dwordx4 v[116:119], v4, s[44:47], 0 offen offset:1280
    buffer_load_dwordx4 v[120:123], v4, s[44:47], 0 offen offset:1920
    buffer_load_dwordx4 v[96:99], v106, s[40:43], 0 offen offset:2560
    buffer_load_dwordx2 v[104:105], v107, s[40:43], 0 offen offset:3584
    ds_read_b128 a[64:67], v142
    ds_read_b128 a[68:71], v142 offset:4096
    ds_read_b64_tr_b16 a[80:81], v146 offset:0
    ds_read_b64_tr_b16 a[82:83], v146 offset:768
    ds_read_b64_tr_b16 a[84:85], v146 offset:32
    ds_read_b64_tr_b16 a[86:87], v146 offset:800
    ds_read_b64_tr_b16 a[88:89], v146 offset:64
    ds_read_b64_tr_b16 a[90:91], v146 offset:832
    s_waitcnt lgkmcnt(0)
    v_mfma_f32_32x32x16_bf16 v[148:163], a[80:83], a[64:67], v[148:163]
    ds_read_b128 a[72:75], v143
    ds_read_b128 a[76:79], v143 offset:4096
    v_mfma_f32_32x32x16_bf16 v[196:211], a[80:83], a[68:71], v[196:211]
    ds_read_b64_tr_b16 a[92:93], v146 offset:3072
    ds_read_b64_tr_b16 a[94:95], v146 offset:3840
    v_mfma_f32_32x32x16_bf16 v[164:179], a[84:87], a[64:67], v[164:179]
    ds_read_b64_tr_b16 a[96:97], v146 offset:3104
    ds_read_b64_tr_b16 a[98:99], v146 offset:3872
    v_mfma_f32_32x32x16_bf16 v[212:227], a[84:87], a[68:71], v[212:227]
    ds_read_b64_tr_b16 a[100:101], v146 offset:3136
    ds_read_b64_tr_b16 a[102:103], v146 offset:3904
    v_mfma_f32_32x32x16_bf16 v[180:195], a[88:91], a[64:67], v[180:195]
    v_mfma_f32_32x32x16_bf16 v[228:243], a[88:91], a[68:71], v[228:243]
    s_waitcnt lgkmcnt(0)
    v_mfma_f32_32x32x16_bf16 v[148:163], a[92:95], a[72:75], v[148:163]
    ds_read_b128 a[64:67], v144
    ds_read_b128 a[68:71], v144 offset:4096
    v_mfma_f32_32x32x16_bf16 v[196:211], a[92:95], a[76:79], v[196:211]
    ds_read_b64_tr_b16 a[80:81], v146 offset:6144
    ds_read_b64_tr_b16 a[82:83], v146 offset:6912
    v_mfma_f32_32x32x16_bf16 v[164:179], a[96:99], a[72:75], v[164:179]
    ds_read_b64_tr_b16 a[84:85], v146 offset:6176
    ds_read_b64_tr_b16 a[86:87], v146 offset:6944
    v_mfma_f32_32x32x16_bf16 v[212:227], a[96:99], a[76:79], v[212:227]
    ds_read_b64_tr_b16 a[88:89], v146 offset:6208
    ds_read_b64_tr_b16 a[90:91], v146 offset:6976
    v_mfma_f32_32x32x16_bf16 v[180:195], a[100:103], a[72:75], v[180:195]
    v_mfma_f32_32x32x16_bf16 v[228:243], a[100:103], a[76:79], v[228:243]
    s_waitcnt lgkmcnt(0)
    v_mfma_f32_32x32x16_bf16 v[148:163], a[80:83], a[64:67], v[148:163]
    ds_read_b128 a[72:75], v145
    ds_read_b128 a[76:79], v145 offset:4096
    v_mfma_f32_32x32x16_bf16 v[196:211], a[80:83], a[68:71], v[196:211]
    ds_read_b64_tr_b16 a[92:93], v146 offset:9216
    ds_read_b64_tr_b16 a[94:95], v146 offset:9984
    v_mfma_f32_32x32x16_bf16 v[164:179], a[84:87], a[64:67], v[164:179]
    ds_read_b64_tr_b16 a[96:97], v146 offset:9248
    ds_read_b64_tr_b16 a[98:99], v146 offset:10016
    v_mfma_f32_32x32x16_bf16 v[212:227], a[84:87], a[68:71], v[212:227]
    ds_read_b64_tr_b16 a[100:101], v146 offset:9280
    ds_read_b64_tr_b16 a[102:103], v146 offset:10048
    v_mfma_f32_32x32x16_bf16 v[180:195], a[88:91], a[64:67], v[180:195]
    v_mfma_f32_32x32x16_bf16 v[228:243], a[88:91], a[68:71], v[228:243]
    s_waitcnt lgkmcnt(0)
    v_mfma_f32_32x32x16_bf16 v[148:163], a[92:95], a[72:75], v[148:163]
    v_mfma_f32_32x32x16_bf16 v[196:211], a[92:95], a[76:79], v[196:211]
    v_mfma_f32_32x32x16_bf16 v[164:179], a[96:99], a[72:75], v[164:179]
    v_mfma_f32_32x32x16_bf16 v[212:227], a[96:99], a[76:79], v[212:227]
    v_mfma_f32_32x32x16_bf16 v[180:195], a[100:103], a[72:75], v[180:195]
    v_mfma_f32_32x32x16_bf16 v[228:243], a[100:103], a[76:79], v[228:243]
    s_mov_b32 s58, 0
    s_mov_b32 s57, 41024
    v_add_u32 v142, s48, v142
    v_add_u32 v143, s48, v143
    v_add_u32 v144, s48, v144
    v_add_u32 v145, s48, v145
    v_add_u32 v146, s48, v146
    s_waitcnt vmcnt(8)
    s_barrier
    ds_read_b128 a[64:67], v142
    ds_read_b128 a[68:71], v142 offset:4096
    ds_read_b64_tr_b16 a[80:81], v146 offset:0
    ds_read_b64_tr_b16 a[82:83], v146 offset:768
    ds_read_b64_tr_b16 a[84:85], v146 offset:32
    ds_read_b64_tr_b16 a[86:87], v146 offset:800
    ds_read_b64_tr_b16 a[88:89], v146 offset:64
    ds_read_b64_tr_b16 a[90:91], v146 offset:832
    s_add_u32 m0, s58, s61
    s_nop 0
    buffer_load_dwordx4 v132, s[72:75], 0 offen offset:0 lds
    buffer_load_dwordx4 v133, s[72:75], 0 offen offset:1024 lds
    s_mul_i32 s53, s52, -3840
    s_add_u32 s53, s53, 38400
    s_add_u32 s52, s52, 1
    s_cmp_eq_u32 s52, 10
    s_cselect_b32 s52, 0, s52
    s_cselect_b32 s50, s54, s55
    s_cmp_eq_u32 s5, 9
    s_cselect_b32 s50, s53, s50
    v_add_u32 v106, s50, v106
    v_add_u32 v107, s50, v107
    v_cmp_eq_u32 vcc, 0, v2
    s_nop 0
    s_waitcnt vmcnt(10)
    v_cndmask_b32 v32, 0, v40, vcc
    v_cndmask_b32 v33, 0, v41, vcc
    v_cndmask_b32 v34, 0, v42, vcc
    v_cndmask_b32 v35, 0, v43, vcc
    v_cndmask_b32 v36, 0, v44, vcc
    v_cndmask_b32 v37, 0, v45, vcc
    v_cndmask_b32 v38, 0, v46, vcc
    v_cndmask_b32 v39, 0, v47, vcc
    s_nop 1
    v_mfma_f32_32x32x16_bf16 v[40:55], v[88:91], v[16:19], 0
    v_mfma_f32_32x32x8_bf16 v[40:55], v[100:101], v[32:33], v[40:55]
    s_nop 7
    s_nop 7
.p2align 6
P2_LOOP:
    v_mfma_f32_32x32x16_bf16 v[56:71], v[88:91], v[20:23], 0
    s_waitcnt lgkmcnt(0)
    ds_read_b128 a[72:75], v143
    v_exp_f32 v40, v40
    v_exp_f32 v41, v41
    v_exp_f32 v42, v42
    v_mfma_f32_32x32x8_bf16 v[56:71], v[100:101], v[34:35], v[56:71]
    v_exp_f32 v43, v43
    v_exp_f32 v44, v44
    v_exp_f32 v45, v45
    v_exp_f32 v46, v46
    v_mfma_f32_32x32x16_bf16 a[48:63], v[124:127], v[80:83], a[48:63]
    s_add_u32 s5, s5, 1
    ds_read_b128 a[76:79], v143 offset:4096
    v_exp_f32 v47, v47
    v_exp_f32 v48, v48
    v_cvt_pk_bf16_f32 v72, v40, v41
    v_cvt_pk_bf16_f32 v73, v42, v43
    v_mfma_f32_32x32x16_bf16 v[148:163], a[80:83], a[64:67], v[148:163]
    ds_read_b64_tr_b16 a[92:93], v146 offset:3072
    v_exp_f32 v49, v49
    v_exp_f32 v50, v50
    v_exp_f32 v51, v51
    v_cvt_pk_bf16_f32 v74, v44, v45
    v_mfma_f32_32x32x16_bf16 a[48:63], v[128:131], v[84:87], a[48:63]
    buffer_load_dwordx4 v134, s[72:75], 0 offen offset:2048 lds
    v_exp_f32 v52, v52
    v_exp_f32 v53, v53
    v_cvt_pk_bf16_f32 v75, v46, v47
    v_cvt_pk_bf16_f32 v76, v48, v49
    v_mfma_f32_32x32x16_bf16 v[196:211], a[80:83], a[68:71], v[196:211]
    s_waitcnt vmcnt(9)
    buffer_load_dwordx4 v135, s[72:75], 0 offen offset:3072 lds
    v_exp_f32 v54, v54
    v_exp_f32 v55, v55
    v_cvt_pk_bf16_f32 v77, v50, v51
    v_cvt_pk_bf16_f32 v78, v52, v53
    v_cvt_pk_bf16_f32 v79, v54, v55
    v_mfma_f32_32x32x16_bf16 v[40:55], v[88:91], v[24:27], 0
    ds_read_b64_tr_b16 a[94:95], v146 offset:3840
    v_exp_f32 v56, v56
    v_exp_f32 v57, v57
    v_exp_f32 v58, v58
    v_mfma_f32_32x32x8_bf16 v[40:55], v[100:101], v[36:37], v[40:55]
    v_exp_f32 v59, v59
    v_exp_f32 v60, v60
    v_exp_f32 v61, v61
    v_exp_f32 v62, v62
    v_mfma_f32_32x32x16_bf16 a[0:15], v[108:111], v[72:75], a[0:15]
    ds_read_b64_tr_b16 a[96:97], v146 offset:3104
    v_exp_f32 v63, v63
    v_exp_f32 v64, v64
    v_cvt_pk_bf16_f32 v80, v56, v57
    v_cvt_pk_bf16_f32 v81, v58, v59
    v_mfma_f32_32x32x16_bf16 v[164:179], a[84:87], a[64:67], v[164:179]
    s_add_u32 m0, s58, s62
    buffer_load_dwordx4 v[124:127], v4, s[44:47], 0 offen offset:2560
    v_exp_f32 v65, v65
    v_exp_f32 v66, v66
    v_exp_f32 v67, v67
    v_cvt_pk_bf16_f32 v82, v60, v61
    v_mfma_f32_32x32x16_bf16 a[0:15], v[112:115], v[76:79], a[0:15]
    buffer_load_dwordx4 v136, s[76:79], 0 offen offset:0 lds
    v_exp_f32 v68, v68
    v_exp_f32 v69, v69
    v_cvt_pk_bf16_f32 v83, v62, v63
    v_cvt_pk_bf16_f32 v84, v64, v65
    v_mfma_f32_32x32x16_bf16 v[212:227], a[84:87], a[68:71], v[212:227]
    s_mov_b32 s49, s57
    buffer_load_dwordx4 v[128:131], v4, s[44:47], 0 offen offset:3200
    v_mad_i32_i24 v4, v5, s50, v4
    v_exp_f32 v70, v70
    v_exp_f32 v71, v71
    v_cvt_pk_bf16_f32 v85, v66, v67
    v_cvt_pk_bf16_f32 v86, v68, v69
    v_cvt_pk_bf16_f32 v87, v70, v71
    v_mfma_f32_32x32x16_bf16 v[56:71], v[88:91], v[28:31], 0
    s_add_u32 s57, s57, 41024
    ds_read_b64_tr_b16 a[98:99], v146 offset:3872
    v_exp_f32 v40, v40
    v_exp_f32 v41, v41
    v_exp_f32 v42, v42
    v_mfma_f32_32x32x8_bf16 v[56:71], v[100:101], v[38:39], v[56:71]
    v_exp_f32 v43, v43
    v_exp_f32 v44, v44
    v_exp_f32 v45, v45
    v_exp_f32 v46, v46
    v_mfma_f32_32x32x16_bf16 a[16:31], v[108:111], v[80:83], a[16:31]
    s_cmp_eq_u32 s57, 123072
    ds_read_b64_tr_b16 a[100:101], v146 offset:3136
    v_exp_f32 v47, v47
    v_exp_f32 v48, v48
    v_cvt_pk_bf16_f32 v72, v40, v41
    v_cvt_pk_bf16_f32 v73, v42, v43
    v_mfma_f32_32x32x16_bf16 v[180:195], a[88:91], a[64:67], v[180:195]
    s_cselect_b32 s57, 0, s57
    ds_read_b64_tr_b16 a[102:103], v146 offset:3904
    v_exp_f32 v49, v49
    v_exp_f32 v50, v50
    v_exp_f32 v51, v51
    v_cvt_pk_bf16_f32 v74, v44, v45
    v_mfma_f32_32x32x16_bf16 a[16:31], v[112:115], v[84:87], a[16:31]
    s_cselect_b32 s56, s71, s48
    buffer_load_dwordx4 v137, s[76:79], 0 offen offset:1024 lds
    v_exp_f32 v52, v52
    v_exp_f32 v53, v53
    v_cvt_pk_bf16_f32 v75, v46, v47
    v_cvt_pk_bf16_f32 v76, v48, v49
    v_mfma_f32_32x32x16_bf16 v[228:243], a[88:91], a[68:71], v[228:243]
    s_waitcnt vmcnt(12)
    v_exp_f32 v54, v54
    v_exp_f32 v55, v55
    v_cvt_pk_bf16_f32 v77, v50, v51
    v_cvt_pk_bf16_f32 v78, v52, v53
    v_cvt_pk_bf16_f32 v79, v54, v55
    v_mfma_f32_32x32x16_bf16 v[40:55], v[92:95], v[16:19], 0
    s_waitcnt lgkmcnt(0)
    ds_read_b128 a[64:67], v144
    v_exp_f32 v56, v56
    v_exp_f32 v57, v57
    v_exp_f32 v58, v58
    v_mfma_f32_32x32x8_bf16 v[40:55], v[102:103], v[32:33], v[40:55]
    v_exp_f32 v59, v59
    v_exp_f32 v60, v60
    v_exp_f32 v61, v61
    v_exp_f32 v62, v62
    v_mfma_f32_32x32x16_bf16 a[32:47], v[108:111], v[72:75], a[32:47]
    s_mul_i32 s53, s52, -3840
    ds_read_b128 a[68:71], v144 offset:4096
    v_exp_f32 v63, v63
    v_exp_f32 v64, v64
    v_cvt_pk_bf16_f32 v80, v56, v57
    v_cvt_pk_bf16_f32 v81, v58, v59
    v_mfma_f32_32x32x16_bf16 v[148:163], a[92:95], a[72:75], v[148:163]
    s_add_u32 s53, s53, 38400
    buffer_load_dwordx4 v[88:91], v106, s[40:43], 0 offen offset:0
    v_exp_f32 v65, v65
    v_exp_f32 v66, v66
    v_exp_f32 v67, v67
    v_cvt_pk_bf16_f32 v82, v60, v61
    v_mfma_f32_32x32x16_bf16 a[32:47], v[112:115], v[76:79], a[32:47]
    s_add_u32 s52, s52, 1
    buffer_load_dwordx4 v138, s[76:79], 0 offen offset:2048 lds
    v_exp_f32 v68, v68
    v_exp_f32 v69, v69
    v_cvt_pk_bf16_f32 v83, v62, v63
    v_cvt_pk_bf16_f32 v84, v64, v65
    v_mfma_f32_32x32x16_bf16 v[196:211], a[92:95], a[76:79], v[196:211]
    s_cmp_eq_u32 s52, 10
    buffer_load_dwordx2 v[100:101], v107, s[40:43], 0 offen offset:1024
    v_exp_f32 v70, v70
    v_exp_f32 v71, v71
    v_cvt_pk_bf16_f32 v85, v66, v67
    v_cvt_pk_bf16_f32 v86, v68, v69
    v_cvt_pk_bf16_f32 v87, v70, v71
    v_mfma_f32_32x32x16_bf16 v[56:71], v[92:95], v[20:23], 0
    s_cselect_b32 s52, 0, s52
    ds_read_b64_tr_b16 a[80:81], v146 offset:6144
    v_exp_f32 v40, v40
    v_exp_f32 v41, v41
    v_exp_f32 v42, v42
    v_mfma_f32_32x32x8_bf16 v[56:71], v[102:103], v[34:35], v[56:71]
    v_exp_f32 v43, v43
    v_exp_f32 v44, v44
    v_exp_f32 v45, v45
    v_exp_f32 v46, v46
    v_mfma_f32_32x32x16_bf16 a[48:63], v[108:111], v[80:83], a[48:63]
    s_cselect_b32 s50, s54, s55
    ds_read_b64_tr_b16 a[82:83], v146 offset:6912
    v_exp_f32 v47, v47
    v_exp_f32 v48, v48
    v_cvt_pk_bf16_f32 v72, v40, v41
    v_cvt_pk_bf16_f32 v73, v42, v43
    v_mfma_f32_32x32x16_bf16 v[164:179], a[96:99], a[72:75], v[164:179]
    s_cmp_eq_u32 s5, 9
    ds_read_b64_tr_b16 a[84:85], v146 offset:6176
    v_exp_f32 v49, v49
    v_exp_f32 v50, v50
    v_exp_f32 v51, v51
    v_cvt_pk_bf16_f32 v74, v44, v45
    v_mfma_f32_32x32x16_bf16 a[48:63], v[112:115], v[84:87], a[48:63]
    s_cselect_b32 s50, s53, s50
    ds_read_b64_tr_b16 a[86:87], v146 offset:6944
    v_exp_f32 v52, v52
    v_exp_f32 v53, v53
    v_cvt_pk_bf16_f32 v75, v46, v47
    v_cvt_pk_bf16_f32 v76, v48, v49
    v_mfma_f32_32x32x16_bf16 v[212:227], a[96:99], a[76:79], v[212:227]
    s_waitcnt vmcnt(13)
    buffer_load_dwordx4 v139, s[76:79], 0 offen offset:3072 lds
    v_exp_f32 v54, v54
    v_exp_f32 v55, v55
    v_cvt_pk_bf16_f32 v77, v50, v51
    v_cvt_pk_bf16_f32 v78, v52, v53
    v_cvt_pk_bf16_f32 v79, v54, v55
    v_mfma_f32_32x32x16_bf16 v[40:55], v[92:95], v[24:27], 0
    ds_read_b64_tr_b16 a[88:89], v146 offset:6208
    v_exp_f32 v56, v56
    v_exp_f32 v57, v57
    v_exp_f32 v58, v58
    v_mfma_f32_32x32x8_bf16 v[40:55], v[102:103], v[36:37], v[40:55]
    v_exp_f32 v59, v59
    v_exp_f32 v60, v60
    v_exp_f32 v61, v61
    v_exp_f32 v62, v62
    v_mfma_f32_32x32x16_bf16 a[0:15], v[116:119], v[72:75], a[0:15]
    ds_read_b64_tr_b16 a[90:91], v146 offset:6976
    v_exp_f32 v63, v63
    v_exp_f32 v64, v64
    v_cvt_pk_bf16_f32 v80, v56, v57
    v_cvt_pk_bf16_f32 v81, v58, v59
    v_mfma_f32_32x32x16_bf16 v[180:195], a[100:103], a[72:75], v[180:195]
    s_add_u32 m0, s58, s63
    buffer_load_dwordx4 v[108:111], v4, s[44:47], 0 offen offset:0
    v_exp_f32 v65, v65
    v_exp_f32 v66, v66
    v_exp_f32 v67, v67
    v_cvt_pk_bf16_f32 v82, v60, v61
    v_mfma_f32_32x32x16_bf16 a[0:15], v[120:123], v[76:79], a[0:15]
    buffer_load_dwordx4 v140, s[76:79], 0 offen offset:0 lds
    v_exp_f32 v68, v68
    v_exp_f32 v69, v69
    v_cvt_pk_bf16_f32 v83, v62, v63
    v_cvt_pk_bf16_f32 v84, v64, v65
    v_mfma_f32_32x32x16_bf16 v[228:243], a[100:103], a[76:79], v[228:243]
    buffer_load_dwordx4 v[112:115], v4, s[44:47], 0 offen offset:640
    v_exp_f32 v70, v70
    v_exp_f32 v71, v71
    v_cvt_pk_bf16_f32 v85, v66, v67
    v_cvt_pk_bf16_f32 v86, v68, v69
    v_cvt_pk_bf16_f32 v87, v70, v71
    v_mfma_f32_32x32x16_bf16 v[56:71], v[92:95], v[28:31], 0
    s_waitcnt lgkmcnt(0)
    ds_read_b128 a[72:75], v145
    v_exp_f32 v40, v40
    v_exp_f32 v41, v41
    v_exp_f32 v42, v42
    v_mfma_f32_32x32x8_bf16 v[56:71], v[102:103], v[38:39], v[56:71]
    v_exp_f32 v43, v43
    v_exp_f32 v44, v44
    v_exp_f32 v45, v45
    v_exp_f32 v46, v46
    v_mfma_f32_32x32x16_bf16 a[16:31], v[116:119], v[80:83], a[16:31]
    ds_read_b128 a[76:79], v145 offset:4096
    v_exp_f32 v47, v47
    v_exp_f32 v48, v48
    v_cvt_pk_bf16_f32 v72, v40, v41
    v_cvt_pk_bf16_f32 v73, v42, v43
    v_mfma_f32_32x32x16_bf16 v[148:163], a[80:83], a[64:67], v[148:163]
    ds_read_b64_tr_b16 a[92:93], v146 offset:9216
    v_exp_f32 v49, v49
    v_exp_f32 v50, v50
    v_exp_f32 v51, v51
    v_cvt_pk_bf16_f32 v74, v44, v45
    v_mfma_f32_32x32x16_bf16 a[16:31], v[120:123], v[84:87], a[16:31]
    ds_read_b64_tr_b16 a[94:95], v146 offset:9984
    v_exp_f32 v52, v52
    v_exp_f32 v53, v53
    v_cvt_pk_bf16_f32 v75, v46, v47
    v_cvt_pk_bf16_f32 v76, v48, v49
    v_mfma_f32_32x32x16_bf16 v[196:211], a[80:83], a[68:71], v[196:211]
    s_waitcnt vmcnt(13)
    buffer_load_dwordx4 v141, s[76:79], 0 offen offset:1024 lds
    v_exp_f32 v54, v54
    v_exp_f32 v55, v55
    v_cvt_pk_bf16_f32 v77, v50, v51
    v_cvt_pk_bf16_f32 v78, v52, v53
    v_cvt_pk_bf16_f32 v79, v54, v55
    v_mfma_f32_32x32x16_bf16 v[40:55], v[96:99], v[16:19], 0
    s_add_u32 s60, s60, 1
    ds_read_b64_tr_b16 a[96:97], v146 offset:9248
    v_exp_f32 v56, v56
    v_exp_f32 v57, v57
    v_exp_f32 v58, v58
    v_mfma_f32_32x32x8_bf16 v[40:55], v[104:105], v[32:33], v[40:55]
    v_exp_f32 v59, v59
    v_exp_f32 v60, v60
    v_exp_f32 v61, v61
    v_exp_f32 v62, v62
    v_mfma_f32_32x32x16_bf16 a[32:47], v[116:119], v[72:75], a[32:47]
    s_cmp_eq_u32 s60, 10
    ds_read_b64_tr_b16 a[98:99], v146 offset:10016
    v_exp_f32 v63, v63
    v_exp_f32 v64, v64
    v_cvt_pk_bf16_f32 v80, v56, v57
    v_cvt_pk_bf16_f32 v81, v58, v59
    v_mfma_f32_32x32x16_bf16 v[164:179], a[84:87], a[64:67], v[164:179]
    s_cselect_b32 s60, 0, s60
    buffer_load_dwordx4 v[92:95], v106, s[40:43], 0 offen offset:1280
    v_exp_f32 v65, v65
    v_exp_f32 v66, v66
    v_exp_f32 v67, v67
    v_cvt_pk_bf16_f32 v82, v60, v61
    v_mfma_f32_32x32x16_bf16 a[32:47], v[120:123], v[76:79], a[32:47]
    s_cselect_b32 s64, s66, s67
    buffer_load_dwordx2 v[102:103], v107, s[40:43], 0 offen offset:2304
    v_exp_f32 v68, v68
    v_exp_f32 v69, v69
    v_cvt_pk_bf16_f32 v83, v62, v63
    v_cvt_pk_bf16_f32 v84, v64, v65
    v_mfma_f32_32x32x16_bf16 v[212:227], a[84:87], a[68:71], v[212:227]
    s_cselect_b32 s65, s68, s69
    v_exp_f32 v70, v70
    v_exp_f32 v71, v71
    v_cvt_pk_bf16_f32 v85, v66, v67
    v_cvt_pk_bf16_f32 v86, v68, v69
    v_cvt_pk_bf16_f32 v87, v70, v71
    v_mfma_f32_32x32x16_bf16 v[56:71], v[96:99], v[20:23], 0
    s_cselect_b32 s70, -1, 0
    ds_read_b64_tr_b16 a[100:101], v146 offset:9280
    v_exp_f32 v40, v40
    v_exp_f32 v41, v41
    v_exp_f32 v42, v42
    v_mfma_f32_32x32x8_bf16 v[56:71], v[104:105], v[34:35], v[56:71]
    v_exp_f32 v43, v43
    v_exp_f32 v44, v44
    v_exp_f32 v45, v45
    v_exp_f32 v46, v46
    v_mfma_f32_32x32x16_bf16 a[48:63], v[116:119], v[80:83], a[48:63]
    s_add_u32 s72, s72, s64
    ds_read_b64_tr_b16 a[102:103], v146 offset:10048
    v_exp_f32 v47, v47
    v_exp_f32 v48, v48
    v_cvt_pk_bf16_f32 v72, v40, v41
    v_cvt_pk_bf16_f32 v73, v42, v43
    v_mfma_f32_32x32x16_bf16 v[180:195], a[88:91], a[64:67], v[180:195]
    s_addc_u32 s73, s73, s70
    v_exp_f32 v49, v49
    v_exp_f32 v50, v50
    v_exp_f32 v51, v51
    v_cvt_pk_bf16_f32 v74, v44, v45
    v_mfma_f32_32x32x16_bf16 a[48:63], v[120:123], v[84:87], a[48:63]
    s_add_u32 s76, s76, s65
    s_addc_u32 s77, s77, s70
    v_exp_f32 v52, v52
    v_exp_f32 v53, v53
    v_cvt_pk_bf16_f32 v75, v46, v47
    v_cvt_pk_bf16_f32 v76, v48, v49
    v_mfma_f32_32x32x16_bf16 v[228:243], a[88:91], a[68:71], v[228:243]
    s_waitcnt vmcnt(11)
    v_exp_f32 v54, v54
    v_exp_f32 v55, v55
    v_cvt_pk_bf16_f32 v77, v50, v51
    v_cvt_pk_bf16_f32 v78, v52, v53
    v_cvt_pk_bf16_f32 v79, v54, v55
    v_add_u32 v142, s56, v142
    v_add_u32 v143, s56, v143
    v_add_u32 v144, s56, v144
    v_add_u32 v145, s56, v145
    v_add_u32 v146, s56, v146
    v_mfma_f32_32x32x16_bf16 v[40:55], v[96:99], v[24:27], 0
    s_waitcnt lgkmcnt(0)
    s_barrier
    ds_read_b128 a[64:67], v142
    v_exp_f32 v56, v56
    v_exp_f32 v57, v57
    v_exp_f32 v58, v58
    v_mfma_f32_32x32x8_bf16 v[40:55], v[104:105], v[36:37], v[40:55]
    v_exp_f32 v59, v59
    v_exp_f32 v60, v60
    v_exp_f32 v61, v61
    v_exp_f32 v62, v62
    v_mfma_f32_32x32x16_bf16 a[0:15], v[124:127], v[72:75], a[0:15]
    s_mov_b32 s58, s49
    ds_read_b128 a[68:71], v142 offset:4096
    v_exp_f32 v63, v63
    v_exp_f32 v64, v64
    v_cvt_pk_bf16_f32 v80, v56, v57
    v_cvt_pk_bf16_f32 v81, v58, v59
    v_mfma_f32_32x32x16_bf16 v[148:163], a[92:95], a[72:75], v[148:163]
    s_cmp_eq_u32 s5, 6
    ds_read_b64_tr_b16 a[80:81], v146 offset:0
    v_exp_f32 v65, v65
    v_exp_f32 v66, v66
    v_exp_f32 v67, v67
    v_cvt_pk_bf16_f32 v82, v60, v61
    v_mfma_f32_32x32x16_bf16 a[0:15], v[128:131], v[76:79], a[0:15]
    s_cselect_b32 s76, s18, s76
    buffer_load_dwordx4 v[116:119], v4, s[44:47], 0 offen offset:1280
    v_exp_f32 v68, v68
    v_exp_f32 v69, v69
    v_cvt_pk_bf16_f32 v83, v62, v63
    v_cvt_pk_bf16_f32 v84, v64, v65
    v_mfma_f32_32x32x16_bf16 v[196:211], a[92:95], a[76:79], v[196:211]
    s_cselect_b32 s77, s19, s77
    buffer_load_dwordx4 v[120:123], v4, s[44:47], 0 offen offset:1920
    v_exp_f32 v70, v70
    v_exp_f32 v71, v71
    v_cvt_pk_bf16_f32 v85, v66, v67
    v_cvt_pk_bf16_f32 v86, v68, v69
    v_cvt_pk_bf16_f32 v87, v70, v71
    v_mfma_f32_32x32x16_bf16 v[56:71], v[96:99], v[28:31], 0
    s_cselect_b32 s60, 0, s60
    ds_read_b64_tr_b16 a[82:83], v146 offset:768
    v_exp_f32 v40, v40
    v_exp_f32 v41, v41
    v_exp_f32 v42, v42
    v_mfma_f32_32x32x8_bf16 v[56:71], v[104:105], v[38:39], v[56:71]
    v_exp_f32 v43, v43
    v_exp_f32 v44, v44
    v_exp_f32 v45, v45
    v_exp_f32 v46, v46
    v_mfma_f32_32x32x16_bf16 a[16:31], v[124:127], v[80:83], a[16:31]
    s_cselect_b32 s74, 0, s74
    ds_read_b64_tr_b16 a[84:85], v146 offset:32
    v_exp_f32 v47, v47
    v_exp_f32 v48, v48
    v_cvt_pk_bf16_f32 v72, v40, v41
    v_cvt_pk_bf16_f32 v73, v42, v43
    v_mfma_f32_32x32x16_bf16 v[164:179], a[96:99], a[72:75], v[164:179]
    ds_read_b64_tr_b16 a[86:87], v146 offset:800
    v_exp_f32 v49, v49
    v_exp_f32 v50, v50
    v_exp_f32 v51, v51
    v_cvt_pk_bf16_f32 v74, v44, v45
    v_mfma_f32_32x32x16_bf16 a[16:31], v[128:131], v[84:87], a[16:31]
    s_add_u32 m0, s58, s61
    ds_read_b64_tr_b16 a[88:89], v146 offset:64
    v_exp_f32 v52, v52
    v_exp_f32 v53, v53
    v_cvt_pk_bf16_f32 v75, v46, v47
    v_cvt_pk_bf16_f32 v76, v48, v49
    v_mfma_f32_32x32x16_bf16 v[212:227], a[96:99], a[76:79], v[212:227]
    s_waitcnt vmcnt(9)
    buffer_load_dwordx4 v132, s[72:75], 0 offen offset:0 lds
    v_exp_f32 v54, v54
    v_exp_f32 v55, v55
    v_cvt_pk_bf16_f32 v77, v50, v51
    v_cvt_pk_bf16_f32 v78, v52, v53
    v_cvt_pk_bf16_f32 v79, v54, v55
    v_mfma_f32_32x32x16_bf16 v[40:55], v[88:91], v[16:19], 0
    ds_read_b64_tr_b16 a[90:91], v146 offset:832
    v_exp_f32 v56, v56
    v_exp_f32 v57, v57
    v_exp_f32 v58, v58
    v_mfma_f32_32x32x8_bf16 v[40:55], v[100:101], v[32:33], v[40:55]
    v_exp_f32 v59, v59
    v_exp_f32 v60, v60
    v_exp_f32 v61, v61
    v_exp_f32 v62, v62
    v_mfma_f32_32x32x16_bf16 a[32:47], v[124:127], v[72:75], a[32:47]
    buffer_load_dwordx4 v[96:99], v106, s[40:43], 0 offen offset:2560
    v_exp_f32 v63, v63
    v_exp_f32 v64, v64
    v_cvt_pk_bf16_f32 v80, v56, v57
    v_cvt_pk_bf16_f32 v81, v58, v59
    v_mfma_f32_32x32x16_bf16 v[180:195], a[100:103], a[72:75], v[180:195]
    s_cmp_lt_u32 s5, 7
    buffer_load_dwordx4 v133, s[72:75], 0 offen offset:1024 lds
    v_exp_f32 v65, v65
    v_exp_f32 v66, v66
    v_exp_f32 v67, v67
    v_cvt_pk_bf16_f32 v82, v60, v61
    v_mfma_f32_32x32x16_bf16 a[32:47], v[128:131], v[76:79], a[32:47]
    buffer_load_dwordx2 v[104:105], v107, s[40:43], 0 offen offset:3584
    v_add_u32 v106, s50, v106
    v_add_u32 v107, s50, v107
    v_exp_f32 v68, v68
    v_exp_f32 v69, v69
    v_cvt_pk_bf16_f32 v83, v62, v63
    v_cvt_pk_bf16_f32 v84, v64, v65
    v_mfma_f32_32x32x16_bf16 v[228:243], a[100:103], a[76:79], v[228:243]
    v_exp_f32 v70, v70
    v_exp_f32 v71, v71
    v_cvt_pk_bf16_f32 v85, v66, v67
    v_cvt_pk_bf16_f32 v86, v68, v69
    v_cvt_pk_bf16_f32 v87, v70, v71
    s_cbranch_scc1 P2_LOOP
P2_AFTER:
    s_mov_b32 s16, 0
    s_movk_i32 s22, 4096
    s_movk_i32 s27, 8192
    s_movk_i32 s17, 12288
    s_movk_i32 s9, 16384
    s_movk_i32 s56, 20480
    s_movk_i32 s56, 20480
    v_mfma_f32_32x32x16_bf16 v[56:71], v[88:91], v[20:23], 0
    s_waitcnt lgkmcnt(0)
    ds_read_b128 a[72:75], v143
    v_exp_f32 v40, v40
    v_exp_f32 v41, v41
    v_exp_f32 v42, v42
    v_mfma_f32_32x32x8_bf16 v[56:71], v[100:101], v[34:35], v[56:71]
    v_exp_f32 v43, v43
    v_exp_f32 v44, v44
    v_exp_f32 v45, v45
    v_exp_f32 v46, v46
    v_mfma_f32_32x32x16_bf16 a[48:63], v[124:127], v[80:83], a[48:63]
    ds_read_b128 a[76:79], v143 offset:4096
    v_exp_f32 v47, v47
    v_exp_f32 v48, v48
    v_cvt_pk_bf16_f32 v72, v40, v41
    v_cvt_pk_bf16_f32 v73, v42, v43
    v_mfma_f32_32x32x16_bf16 v[148:163], a[80:83], a[64:67], v[148:163]
    ds_read_b64_tr_b16 a[92:93], v146 offset:3072
    v_exp_f32 v49, v49
    v_exp_f32 v50, v50
    v_exp_f32 v51, v51
    v_cvt_pk_bf16_f32 v74, v44, v45
    v_mfma_f32_32x32x16_bf16 a[48:63], v[128:131], v[84:87], a[48:63]
    buffer_load_dwordx4 a[104:107], v244, s[28:31], s22 offen offset:0 sc1
    v_exp_f32 v52, v52
    v_exp_f32 v53, v53
    v_cvt_pk_bf16_f32 v75, v46, v47
    v_cvt_pk_bf16_f32 v76, v48, v49
    v_mfma_f32_32x32x16_bf16 v[196:211], a[80:83], a[68:71], v[196:211]
    s_waitcnt vmcnt(10)
    buffer_load_dwordx4 a[108:111], v245, s[28:31], s22 offen offset:0 sc1
    v_exp_f32 v54, v54
    v_exp_f32 v55, v55
    v_cvt_pk_bf16_f32 v77, v50, v51
    v_cvt_pk_bf16_f32 v78, v52, v53
    v_cvt_pk_bf16_f32 v79, v54, v55
    v_mfma_f32_32x32x16_bf16 v[40:55], v[88:91], v[24:27], 0
    ds_read_b64_tr_b16 a[94:95], v146 offset:3840
    v_exp_f32 v56, v56
    v_exp_f32 v57, v57
    v_exp_f32 v58, v58
    v_mfma_f32_32x32x8_bf16 v[40:55], v[100:101], v[36:37], v[40:55]
    v_exp_f32 v59, v59
    v_exp_f32 v60, v60
    v_exp_f32 v61, v61
    v_exp_f32 v62, v62
    v_mfma_f32_32x32x16_bf16 a[0:15], v[108:111], v[72:75], a[0:15]
    ds_read_b64_tr_b16 a[96:97], v146 offset:3104
    v_exp_f32 v63, v63
    v_exp_f32 v64, v64
    v_cvt_pk_bf16_f32 v80, v56, v57
    v_cvt_pk_bf16_f32 v81, v58, v59
    v_mfma_f32_32x32x16_bf16 v[164:179], a[84:87], a[64:67], v[164:179]
    buffer_load_dwordx4 v[124:127], v4, s[44:47], 0 offen offset:2560
    v_exp_f32 v65, v65
    v_exp_f32 v66, v66
    v_exp_f32 v67, v67
    v_cvt_pk_bf16_f32 v82, v60, v61
    v_mfma_f32_32x32x16_bf16 a[0:15], v[112:115], v[76:79], a[0:15]
    buffer_load_dwordx4 v[128:131], v4, s[44:47], 0 offen offset:3200
    v_mad_i32_i24 v4, v5, s50, v4
    v_exp_f32 v68, v68
    v_exp_f32 v69, v69
    v_cvt_pk_bf16_f32 v83, v62, v63
    v_cvt_pk_bf16_f32 v84, v64, v65
    v_mfma_f32_32x32x16_bf16 v[212:227], a[84:87], a[68:71], v[212:227]
    buffer_load_dwordx4 a[112:115], v246, s[28:31], s22 offen offset:0 sc1
    v_exp_f32 v70, v70
    v_exp_f32 v71, v71
    v_cvt_pk_bf16_f32 v85, v66, v67
    v_cvt_pk_bf16_f32 v86, v68, v69
    v_cvt_pk_bf16_f32 v87, v70, v71
    v_mfma_f32_32x32x16_bf16 v[56:71], v[88:91], v[28:31], 0
    s_add_u32 s5, s5, 1
    ds_read_b64_tr_b16 a[98:99], v146 offset:3872
    v_exp_f32 v40, v40
    v_exp_f32 v41, v41
    v_exp_f32 v42, v42
    v_mfma_f32_32x32x8_bf16 v[56:71], v[100:101], v[38:39], v[56:71]
    v_exp_f32 v43, v43
    v_exp_f32 v44, v44
    v_exp_f32 v45, v45
    v_exp_f32 v46, v46
    v_mfma_f32_32x32x16_bf16 a[16:31], v[108:111], v[80:83], a[16:31]
    s_mul_i32 s53, s52, -3840
    ds_read_b64_tr_b16 a[100:101], v146 offset:3136
    v_exp_f32 v47, v47
    v_exp_f32 v48, v48
    v_cvt_pk_bf16_f32 v72, v40, v41
    v_cvt_pk_bf16_f32 v73, v42, v43
    v_mfma_f32_32x32x16_bf16 v[180:195], a[88:91], a[64:67], v[180:195]
    s_add_u32 s53, s53, 38400
    ds_read_b64_tr_b16 a[102:103], v146 offset:3904
    v_exp_f32 v49, v49
    v_exp_f32 v50, v50
    v_exp_f32 v51, v51
    v_cvt_pk_bf16_f32 v74, v44, v45
    v_mfma_f32_32x32x16_bf16 a[16:31], v[112:115], v[84:87], a[16:31]
    s_add_u32 s52, s52, 1
    buffer_load_dwordx4 a[116:119], v247, s[28:31], s22 offen offset:0 sc1
    v_exp_f32 v52, v52
    v_exp_f32 v53, v53
    v_cvt_pk_bf16_f32 v75, v46, v47
    v_cvt_pk_bf16_f32 v76, v48, v49
    v_mfma_f32_32x32x16_bf16 v[228:243], a[88:91], a[68:71], v[228:243]
    s_waitcnt vmcnt(12)
    buffer_load_dwordx4 a[120:123], v248, s[28:31], s22 offen offset:0 sc1
    v_exp_f32 v54, v54
    v_exp_f32 v55, v55
    v_cvt_pk_bf16_f32 v77, v50, v51
    v_cvt_pk_bf16_f32 v78, v52, v53
    v_cvt_pk_bf16_f32 v79, v54, v55
    v_mfma_f32_32x32x16_bf16 v[40:55], v[92:95], v[16:19], 0
    s_waitcnt lgkmcnt(0)
    ds_read_b128 a[64:67], v144
    v_exp_f32 v56, v56
    v_exp_f32 v57, v57
    v_exp_f32 v58, v58
    v_mfma_f32_32x32x8_bf16 v[40:55], v[102:103], v[32:33], v[40:55]
    v_exp_f32 v59, v59
    v_exp_f32 v60, v60
    v_exp_f32 v61, v61
    v_exp_f32 v62, v62
    v_mfma_f32_32x32x16_bf16 a[32:47], v[108:111], v[72:75], a[32:47]
    s_cmp_eq_u32 s52, 10
    ds_read_b128 a[68:71], v144 offset:4096
    v_exp_f32 v63, v63
    v_exp_f32 v64, v64
    v_cvt_pk_bf16_f32 v80, v56, v57
    v_cvt_pk_bf16_f32 v81, v58, v59
    v_mfma_f32_32x32x16_bf16 v[148:163], a[92:95], a[72:75], v[148:163]
    s_cselect_b32 s52, 0, s52
    buffer_load_dwordx4 v[88:91], v106, s[40:43], 0 offen offset:0
    v_exp_f32 v65, v65
    v_exp_f32 v66, v66
    v_exp_f32 v67, v67
    v_cvt_pk_bf16_f32 v82, v60, v61
    v_mfma_f32_32x32x16_bf16 a[32:47], v[112:115], v[76:79], a[32:47]
    s_cselect_b32 s50, s54, s55
    buffer_load_dwordx2 v[100:101], v107, s[40:43], 0 offen offset:1024
    v_exp_f32 v68, v68
    v_exp_f32 v69, v69
    v_cvt_pk_bf16_f32 v83, v62, v63
    v_cvt_pk_bf16_f32 v84, v64, v65
    v_mfma_f32_32x32x16_bf16 v[196:211], a[92:95], a[76:79], v[196:211]
    s_cmp_eq_u32 s5, 9
    buffer_load_dwordx4 a[124:127], v244, s[28:31], s22 offen offset:2048 sc1
    v_exp_f32 v70, v70
    v_exp_f32 v71, v71
    v_cvt_pk_bf16_f32 v85, v66, v67
    v_cvt_pk_bf16_f32 v86, v68, v69
    v_cvt_pk_bf16_f32 v87, v70, v71
    v_mfma_f32_32x32x16_bf16 v[56:71], v[92:95], v[20:23], 0
    s_cselect_b32 s50, s53, s50
    ds_read_b64_tr_b16 a[80:81], v146 offset:6144
    v_exp_f32 v40, v40
    v_exp_f32 v41, v41
    v_exp_f32 v42, v42
    v_mfma_f32_32x32x8_bf16 v[56:71], v[102:103], v[34:35], v[56:71]
    v_exp_f32 v43, v43
    v_exp_f32 v44, v44
    v_exp_f32 v45, v45
    v_exp_f32 v46, v46
    v_mfma_f32_32x32x16_bf16 a[48:63], v[108:111], v[80:83], a[48:63]
    ds_read_b64_tr_b16 a[82:83], v146 offset:6912
    v_exp_f32 v47, v47
    v_exp_f32 v48, v48
    v_cvt_pk_bf16_f32 v72, v40, v41
    v_cvt_pk_bf16_f32 v73, v42, v43
    v_mfma_f32_32x32x16_bf16 v[164:179], a[96:99], a[72:75], v[164:179]
    ds_read_b64_tr_b16 a[84:85], v146 offset:6176
    v_exp_f32 v49, v49
    v_exp_f32 v50, v50
    v_exp_f32 v51, v51
    v_cvt_pk_bf16_f32 v74, v44, v45
    v_mfma_f32_32x32x16_bf16 a[48:63], v[112:115], v[84:87], a[48:63]
    ds_read_b64_tr_b16 a[86:87], v146 offset:6944
    v_exp_f32 v52, v52
    v_exp_f32 v53, v53
    v_cvt_pk_bf16_f32 v75, v46, v47
    v_cvt_pk_bf16_f32 v76, v48, v49
    v_mfma_f32_32x32x16_bf16 v[212:227], a[96:99], a[76:79], v[212:227]
    s_waitcnt vmcnt(14)
    buffer_load_dwordx4 a[128:131], v245, s[28:31], s22 offen offset:2048 sc1
    v_exp_f32 v54, v54
    v_exp_f32 v55, v55
    v_cvt_pk_bf16_f32 v77, v50, v51
    v_cvt_pk_bf16_f32 v78, v52, v53
    v_cvt_pk_bf16_f32 v79, v54, v55
    v_mfma_f32_32x32x16_bf16 v[40:55], v[92:95], v[24:27], 0
    ds_read_b64_tr_b16 a[88:89], v146 offset:6208
    v_exp_f32 v56, v56
    v_exp_f32 v57, v57
    v_exp_f32 v58, v58
    v_mfma_f32_32x32x8_bf16 v[40:55], v[102:103], v[36:37], v[40:55]
    v_exp_f32 v59, v59
    v_exp_f32 v60, v60
    v_exp_f32 v61, v61
    v_exp_f32 v62, v62
    v_mfma_f32_32x32x16_bf16 a[0:15], v[116:119], v[72:75], a[0:15]
    ds_read_b64_tr_b16 a[90:91], v146 offset:6976
    v_exp_f32 v63, v63
    v_exp_f32 v64, v64
    v_cvt_pk_bf16_f32 v80, v56, v57
    v_cvt_pk_bf16_f32 v81, v58, v59
    v_mfma_f32_32x32x16_bf16 v[180:195], a[100:103], a[72:75], v[180:195]
    buffer_load_dwordx4 v[108:111], v4, s[44:47], 0 offen offset:0
    v_exp_f32 v65, v65
    v_exp_f32 v66, v66
    v_exp_f32 v67, v67
    v_cvt_pk_bf16_f32 v82, v60, v61
    v_mfma_f32_32x32x16_bf16 a[0:15], v[120:123], v[76:79], a[0:15]
    buffer_load_dwordx4 v[112:115], v4, s[44:47], 0 offen offset:640
    v_exp_f32 v68, v68
    v_exp_f32 v69, v69
    v_cvt_pk_bf16_f32 v83, v62, v63
    v_cvt_pk_bf16_f32 v84, v64, v65
    v_mfma_f32_32x32x16_bf16 v[228:243], a[100:103], a[76:79], v[228:243]
    buffer_load_dwordx4 a[132:135], v246, s[28:31], s22 offen offset:2048 sc1
    v_exp_f32 v70, v70
    v_exp_f32 v71, v71
    v_cvt_pk_bf16_f32 v85, v66, v67
    v_cvt_pk_bf16_f32 v86, v68, v69
    v_cvt_pk_bf16_f32 v87, v70, v71
    v_mfma_f32_32x32x16_bf16 v[56:71], v[92:95], v[28:31], 0
    s_waitcnt lgkmcnt(0)
    ds_read_b128 a[72:75], v145
    v_exp_f32 v40, v40
    v_exp_f32 v41, v41
    v_exp_f32 v42, v42
    v_mfma_f32_32x32x8_bf16 v[56:71], v[102:103], v[38:39], v[56:71]
    v_exp_f32 v43, v43
    v_exp_f32 v44, v44
    v_exp_f32 v45, v45
    v_exp_f32 v46, v46
    v_mfma_f32_32x32x16_bf16 a[16:31], v[116:119], v[80:83], a[16:31]
    ds_read_b128 a[76:79], v145 offset:4096
    v_exp_f32 v47, v47
    v_exp_f32 v48, v48
    v_cvt_pk_bf16_f32 v72, v40, v41
    v_cvt_pk_bf16_f32 v73, v42, v43
    v_mfma_f32_32x32x16_bf16 v[148:163], a[80:83], a[64:67], v[148:163]
    ds_read_b64_tr_b16 a[92:93], v146 offset:9216
    v_exp_f32 v49, v49
    v_exp_f32 v50, v50
    v_exp_f32 v51, v51
    v_cvt_pk_bf16_f32 v74, v44, v45
    v_mfma_f32_32x32x16_bf16 a[16:31], v[120:123], v[84:87], a[16:31]
    ds_read_b64_tr_b16 a[94:95], v146 offset:9984
    v_exp_f32 v52, v52
    v_exp_f32 v53, v53
    v_cvt_pk_bf16_f32 v75, v46, v47
    v_cvt_pk_bf16_f32 v76, v48, v49
    v_mfma_f32_32x32x16_bf16 v[196:211], a[80:83], a[68:71], v[196:211]
    s_waitcnt vmcnt(14)
    buffer_load_dwordx4 a[136:139], v247, s[28:31], s22 offen offset:2048 sc1
    v_exp_f32 v54, v54
    v_exp_f32 v55, v55
    v_cvt_pk_bf16_f32 v77, v50, v51
    v_cvt_pk_bf16_f32 v78, v52, v53
    v_cvt_pk_bf16_f32 v79, v54, v55
    v_mfma_f32_32x32x16_bf16 v[40:55], v[96:99], v[16:19], 0
    ds_read_b64_tr_b16 a[96:97], v146 offset:9248
    v_exp_f32 v56, v56
    v_exp_f32 v57, v57
    v_exp_f32 v58, v58
    v_mfma_f32_32x32x8_bf16 v[40:55], v[104:105], v[32:33], v[40:55]
    v_exp_f32 v59, v59
    v_exp_f32 v60, v60
    v_exp_f32 v61, v61
    v_exp_f32 v62, v62
    v_mfma_f32_32x32x16_bf16 a[32:47], v[116:119], v[72:75], a[32:47]
    ds_read_b64_tr_b16 a[98:99], v146 offset:10016
    v_exp_f32 v63, v63
    v_exp_f32 v64, v64
    v_cvt_pk_bf16_f32 v80, v56, v57
    v_cvt_pk_bf16_f32 v81, v58, v59
    v_mfma_f32_32x32x16_bf16 v[164:179], a[84:87], a[64:67], v[164:179]
    buffer_load_dwordx4 v[92:95], v106, s[40:43], 0 offen offset:1280
    v_exp_f32 v65, v65
    v_exp_f32 v66, v66
    v_exp_f32 v67, v67
    v_cvt_pk_bf16_f32 v82, v60, v61
    v_mfma_f32_32x32x16_bf16 a[32:47], v[120:123], v[76:79], a[32:47]
    buffer_load_dwordx2 v[102:103], v107, s[40:43], 0 offen offset:2304
    v_exp_f32 v68, v68
    v_exp_f32 v69, v69
    v_cvt_pk_bf16_f32 v83, v62, v63
    v_cvt_pk_bf16_f32 v84, v64, v65
    v_mfma_f32_32x32x16_bf16 v[212:227], a[84:87], a[68:71], v[212:227]
    buffer_load_dwordx4 a[140:143], v248, s[28:31], s22 offen offset:2048 sc1
    v_exp_f32 v70, v70
    v_exp_f32 v71, v71
    v_cvt_pk_bf16_f32 v85, v66, v67
    v_cvt_pk_bf16_f32 v86, v68, v69
    v_cvt_pk_bf16_f32 v87, v70, v71
    v_mfma_f32_32x32x16_bf16 v[56:71], v[96:99], v[20:23], 0
    ds_read_b64_tr_b16 a[100:101], v146 offset:9280
    v_exp_f32 v40, v40
    v_exp_f32 v41, v41
    v_exp_f32 v42, v42
    v_mfma_f32_32x32x8_bf16 v[56:71], v[104:105], v[34:35], v[56:71]
    v_exp_f32 v43, v43
    v_exp_f32 v44, v44
    v_exp_f32 v45, v45
    v_exp_f32 v46, v46
    v_mfma_f32_32x32x16_bf16 a[48:63], v[116:119], v[80:83], a[48:63]
    ds_read_b64_tr_b16 a[102:103], v146 offset:10048
    v_exp_f32 v47, v47
    v_exp_f32 v48, v48
    v_cvt_pk_bf16_f32 v72, v40, v41
    v_cvt_pk_bf16_f32 v73, v42, v43
    v_mfma_f32_32x32x16_bf16 v[180:195], a[88:91], a[64:67], v[180:195]
    buffer_load_dwordx4 a[144:147], v244, s[28:31], s27 offen offset:0 sc1
    v_exp_f32 v49, v49
    v_exp_f32 v50, v50
    v_exp_f32 v51, v51
    v_cvt_pk_bf16_f32 v74, v44, v45
    v_mfma_f32_32x32x16_bf16 a[48:63], v[120:123], v[84:87], a[48:63]
    buffer_load_dwordx4 a[148:151], v245, s[28:31], s27 offen offset:0 sc1
    v_exp_f32 v52, v52
    v_exp_f32 v53, v53
    v_cvt_pk_bf16_f32 v75, v46, v47
    v_cvt_pk_bf16_f32 v76, v48, v49
    v_mfma_f32_32x32x16_bf16 v[228:243], a[88:91], a[68:71], v[228:243]
    s_waitcnt vmcnt(16)
    buffer_load_dwordx4 a[152:155], v246, s[28:31], s27 offen offset:0 sc1
    v_exp_f32 v54, v54
    v_exp_f32 v55, v55
    v_cvt_pk_bf16_f32 v77, v50, v51
    v_cvt_pk_bf16_f32 v78, v52, v53
    v_cvt_pk_bf16_f32 v79, v54, v55
    v_mfma_f32_32x32x16_bf16 v[40:55], v[96:99], v[24:27], 0
    s_waitcnt lgkmcnt(0)
    buffer_load_dwordx4 v[116:119], v4, s[44:47], 0 offen offset:1280
    v_exp_f32 v56, v56
    v_exp_f32 v57, v57
    v_exp_f32 v58, v58
    v_mfma_f32_32x32x8_bf16 v[40:55], v[104:105], v[36:37], v[40:55]
    v_exp_f32 v59, v59
    v_exp_f32 v60, v60
    v_exp_f32 v61, v61
    v_exp_f32 v62, v62
    v_mfma_f32_32x32x16_bf16 a[0:15], v[124:127], v[72:75], a[0:15]
    buffer_load_dwordx4 v[120:123], v4, s[44:47], 0 offen offset:1920
    v_exp_f32 v63, v63
    v_exp_f32 v64, v64
    v_cvt_pk_bf16_f32 v80, v56, v57
    v_cvt_pk_bf16_f32 v81, v58, v59
    v_mfma_f32_32x32x16_bf16 v[148:163], a[92:95], a[72:75], v[148:163]
    buffer_load_dwordx4 a[156:159], v247, s[28:31], s27 offen offset:0 sc1
    v_exp_f32 v65, v65
    v_exp_f32 v66, v66
    v_exp_f32 v67, v67
    v_cvt_pk_bf16_f32 v82, v60, v61
    v_mfma_f32_32x32x16_bf16 a[0:15], v[128:131], v[76:79], a[0:15]
    buffer_load_dwordx4 a[160:163], v248, s[28:31], s27 offen offset:0 sc1
    v_exp_f32 v68, v68
    v_exp_f32 v69, v69
    v_cvt_pk_bf16_f32 v83, v62, v63
    v_cvt_pk_bf16_f32 v84, v64, v65
    v_mfma_f32_32x32x16_bf16 v[196:211], a[92:95], a[76:79], v[196:211]
    buffer_load_dwordx4 a[164:167], v244, s[28:31], s27 offen offset:2048 sc1
    v_exp_f32 v70, v70
    v_exp_f32 v71, v71
    v_cvt_pk_bf16_f32 v85, v66, v67
    v_cvt_pk_bf16_f32 v86, v68, v69
    v_cvt_pk_bf16_f32 v87, v70, v71
    v_mfma_f32_32x32x16_bf16 v[56:71], v[96:99], v[28:31], 0
    buffer_load_dwordx4 a[168:171], v245, s[28:31], s27 offen offset:2048 sc1
    v_exp_f32 v40, v40
    v_exp_f32 v41, v41
    v_exp_f32 v42, v42
    v_mfma_f32_32x32x8_bf16 v[56:71], v[104:105], v[38:39], v[56:71]
    v_exp_f32 v43, v43
    v_exp_f32 v44, v44
    v_exp_f32 v45, v45
    v_exp_f32 v46, v46
    v_mfma_f32_32x32x16_bf16 a[16:31], v[124:127], v[80:83], a[16:31]
    buffer_load_dwordx4 a[172:175], v246, s[28:31], s27 offen offset:2048 sc1
    v_exp_f32 v47, v47
    v_exp_f32 v48, v48
    v_cvt_pk_bf16_f32 v72, v40, v41
    v_cvt_pk_bf16_f32 v73, v42, v43
    v_mfma_f32_32x32x16_bf16 v[164:179], a[96:99], a[72:75], v[164:179]
    buffer_load_dwordx4 a[176:179], v247, s[28:31], s27 offen offset:2048 sc1
    v_exp_f32 v49, v49
    v_exp_f32 v50, v50
    v_exp_f32 v51, v51
    v_cvt_pk_bf16_f32 v74, v44, v45
    v_mfma_f32_32x32x16_bf16 a[16:31], v[128:131], v[84:87], a[16:31]
    buffer_load_dwordx4 a[180:183], v248, s[28:31], s27 offen offset:2048 sc1
    v_exp_f32 v52, v52
    v_exp_f32 v53, v53
    v_cvt_pk_bf16_f32 v75, v46, v47
    v_cvt_pk_bf16_f32 v76, v48, v49
    v_mfma_f32_32x32x16_bf16 v[212:227], a[96:99], a[76:79], v[212:227]
    s_waitcnt vmcnt(21)
    buffer_load_dwordx4 a[184:187], v244, s[28:31], s17 offen offset:0 sc1
    v_exp_f32 v54, v54
    v_exp_f32 v55, v55
    v_cvt_pk_bf16_f32 v77, v50, v51
    v_cvt_pk_bf16_f32 v78, v52, v53
    v_cvt_pk_bf16_f32 v79, v54, v55
    v_mfma_f32_32x32x16_bf16 v[40:55], v[88:91], v[16:19], 0
    buffer_load_dwordx4 v[96:99], v106, s[40:43], 0 offen offset:2560
    v_exp_f32 v56, v56
    v_exp_f32 v57, v57
    v_exp_f32 v58, v58
    v_mfma_f32_32x32x8_bf16 v[40:55], v[100:101], v[32:33], v[40:55]
    v_exp_f32 v59, v59
    v_exp_f32 v60, v60
    v_exp_f32 v61, v61
    v_exp_f32 v62, v62
    v_mfma_f32_32x32x16_bf16 a[32:47], v[124:127], v[72:75], a[32:47]
    buffer_load_dwordx2 v[104:105], v107, s[40:43], 0 offen offset:3584
    v_add_u32 v106, s50, v106
    v_add_u32 v107, s50, v107
    v_exp_f32 v63, v63
    v_exp_f32 v64, v64
    v_cvt_pk_bf16_f32 v80, v56, v57
    v_cvt_pk_bf16_f32 v81, v58, v59
    v_mfma_f32_32x32x16_bf16 v[180:195], a[100:103], a[72:75], v[180:195]
    buffer_load_dwordx4 a[188:191], v245, s[28:31], s17 offen offset:0 sc1
    v_exp_f32 v65, v65
    v_exp_f32 v66, v66
    v_exp_f32 v67, v67
    v_cvt_pk_bf16_f32 v82, v60, v61
    v_mfma_f32_32x32x16_bf16 a[32:47], v[128:131], v[76:79], a[32:47]
    buffer_load_dwordx4 a[192:195], v246, s[28:31], s17 offen offset:0 sc1
    v_exp_f32 v68, v68
    v_exp_f32 v69, v69
    v_cvt_pk_bf16_f32 v83, v62, v63
    v_cvt_pk_bf16_f32 v84, v64, v65
    v_mfma_f32_32x32x16_bf16 v[228:243], a[100:103], a[76:79], v[228:243]
    buffer_load_dwordx4 a[196:199], v247, s[28:31], s17 offen offset:0 sc1
    v_exp_f32 v70, v70
    v_exp_f32 v71, v71
    v_cvt_pk_bf16_f32 v85, v66, v67
    v_cvt_pk_bf16_f32 v86, v68, v69
    v_cvt_pk_bf16_f32 v87, v70, v71
    s_mov_b32 s12, 0xbdd2d3e8
    s_mov_b32 s13, 0xbdd2d3e8
    v_mov_b32 v140, 0xc0135761
    v_mov_b32 v141, 0xc0135761
    s_lshl_b32 s14, s24, 2
    s_lshl_b32 s15, s8, 1
    s_add_u32 s14, s14, s15
    s_mul_i32 s14, s14, 96
    s_mul_i32 s15, s25, 6
    s_add_u32 s14, s14, s15
    s_mul_i32 s15, s35, 3
    s_add_u32 s14, s14, s15
    s_lshl_b32 s14, s14, 10
    s_add_u32 s14, s14, 0x900000
    s_add_u32 s15, s14, 98304
    v_max_f32 v250, 0x0d800000, v250
    v_max_f32 v251, 0x0d800000, v251
    v_rcp_f32 v250, v250
    v_rcp_f32 v251, v251
    v_pk_mul_f32 v[132:133], v[148:149], v[148:149]
    v_pk_mul_f32 v[134:135], v[150:151], v[150:151]
    v_pk_mul_f32 v[136:137], v[152:153], v[152:153]
    v_pk_mul_f32 v[138:139], v[154:155], v[154:155]
    v_pk_fma_f32 v[132:133], v[132:133], s[12:13], v[140:141]
    v_pk_fma_f32 v[134:135], v[134:135], s[12:13], v[140:141]
    v_pk_fma_f32 v[136:137], v[136:137], s[12:13], v[140:141]
    v_pk_fma_f32 v[138:139], v[138:139], s[12:13], v[140:141]
    v_pk_mul_f32 v[132:133], v[132:133], v[148:149]
    v_pk_mul_f32 v[134:135], v[134:135], v[150:151]
    v_pk_mul_f32 v[136:137], v[136:137], v[152:153]
    v_pk_mul_f32 v[138:139], v[138:139], v[154:155]
    v_exp_f32 v132, v132
    v_exp_f32 v133, v133
    v_exp_f32 v134, v134
    v_exp_f32 v135, v135
    v_exp_f32 v136, v136
    v_exp_f32 v137, v137
    v_exp_f32 v138, v138
    v_exp_f32 v139, v139
    v_pk_mul_f32 v[156:157], v[156:157], v[148:149]
    v_pk_mul_f32 v[158:159], v[158:159], v[150:151]
    v_pk_mul_f32 v[160:161], v[160:161], v[152:153]
    v_pk_mul_f32 v[162:163], v[162:163], v[154:155]
    v_pk_fma_f32 v[132:133], v[132:133], v[250:251], v[250:251] op_sel:[0,0,0] op_sel_hi:[1,0,0]
    v_pk_fma_f32 v[134:135], v[134:135], v[250:251], v[250:251] op_sel:[0,0,0] op_sel_hi:[1,0,0]
    v_pk_fma_f32 v[136:137], v[136:137], v[250:251], v[250:251] op_sel:[0,0,0] op_sel_hi:[1,0,0]
    v_pk_fma_f32 v[138:139], v[138:139], v[250:251], v[250:251] op_sel:[0,0,0] op_sel_hi:[1,0,0]
    v_rcp_f32 v132, v132
    v_rcp_f32 v133, v133
    v_rcp_f32 v134, v134
    v_rcp_f32 v135, v135
    v_rcp_f32 v136, v136
    v_rcp_f32 v137, v137
    v_rcp_f32 v138, v138
    v_rcp_f32 v139, v139
    s_nop 0
    v_pk_mul_f32 v[156:157], v[156:157], v[132:133]
    v_pk_mul_f32 v[158:159], v[158:159], v[134:135]
    v_pk_mul_f32 v[160:161], v[160:161], v[136:137]
    v_pk_mul_f32 v[162:163], v[162:163], v[138:139]
    v_cvt_pk_bf16_f32 v148, v156, v157
    v_cvt_pk_bf16_f32 v149, v158, v159
    v_cvt_pk_bf16_f32 v150, v160, v161
    v_cvt_pk_bf16_f32 v151, v162, v163
    buffer_store_dwordx4 v[148:151], v3, s[28:31], s14 offen offset:0 sc1
    v_pk_mul_f32 v[132:133], v[196:197], v[196:197]
    v_pk_mul_f32 v[134:135], v[198:199], v[198:199]
    v_pk_mul_f32 v[136:137], v[200:201], v[200:201]
    v_pk_mul_f32 v[138:139], v[202:203], v[202:203]
    v_pk_fma_f32 v[132:133], v[132:133], s[12:13], v[140:141]
    v_pk_fma_f32 v[134:135], v[134:135], s[12:13], v[140:141]
    v_pk_fma_f32 v[136:137], v[136:137], s[12:13], v[140:141]
    v_pk_fma_f32 v[138:139], v[138:139], s[12:13], v[140:141]
    v_pk_mul_f32 v[132:133], v[132:133], v[196:197]
    v_pk_mul_f32 v[134:135], v[134:135], v[198:199]
    v_pk_mul_f32 v[136:137], v[136:137], v[200:201]
    v_pk_mul_f32 v[138:139], v[138:139], v[202:203]
    v_exp_f32 v132, v132
    v_exp_f32 v133, v133
    v_exp_f32 v134, v134
    v_exp_f32 v135, v135
    v_exp_f32 v136, v136
    v_exp_f32 v137, v137
    v_exp_f32 v138, v138
    v_exp_f32 v139, v139
    v_pk_mul_f32 v[204:205], v[204:205], v[196:197]
    v_pk_mul_f32 v[206:207], v[206:207], v[198:199]
    v_pk_mul_f32 v[208:209], v[208:209], v[200:201]
    v_pk_mul_f32 v[210:211], v[210:211], v[202:203]
    v_pk_fma_f32 v[132:133], v[132:133], v[250:251], v[250:251] op_sel:[0,1,1] op_sel_hi:[1,1,1]
    v_pk_fma_f32 v[134:135], v[134:135], v[250:251], v[250:251] op_sel:[0,1,1] op_sel_hi:[1,1,1]
    v_pk_fma_f32 v[136:137], v[136:137], v[250:251], v[250:251] op_sel:[0,1,1] op_sel_hi:[1,1,1]
    v_pk_fma_f32 v[138:139], v[138:139], v[250:251], v[250:251] op_sel:[0,1,1] op_sel_hi:[1,1,1]
    v_rcp_f32 v132, v132
    v_rcp_f32 v133, v133
    v_rcp_f32 v134, v134
    v_rcp_f32 v135, v135
    v_rcp_f32 v136, v136
    v_rcp_f32 v137, v137
    v_rcp_f32 v138, v138
    v_rcp_f32 v139, v139
    s_nop 0
    v_pk_mul_f32 v[204:205], v[204:205], v[132:133]
    v_pk_mul_f32 v[206:207], v[206:207], v[134:135]
    v_pk_mul_f32 v[208:209], v[208:209], v[136:137]
    v_pk_mul_f32 v[210:211], v[210:211], v[138:139]
    v_cvt_pk_bf16_f32 v196, v204, v205
    v_cvt_pk_bf16_f32 v197, v206, v207
    v_cvt_pk_bf16_f32 v198, v208, v209
    v_cvt_pk_bf16_f32 v199, v210, v211
    buffer_store_dwordx4 v[196:199], v3, s[28:31], s15 offen offset:0 sc1
    v_pk_mul_f32 v[132:133], v[164:165], v[164:165]
    v_pk_mul_f32 v[134:135], v[166:167], v[166:167]
    v_pk_mul_f32 v[136:137], v[168:169], v[168:169]
    v_pk_mul_f32 v[138:139], v[170:171], v[170:171]
    v_pk_fma_f32 v[132:133], v[132:133], s[12:13], v[140:141]
    v_pk_fma_f32 v[134:135], v[134:135], s[12:13], v[140:141]
    v_pk_fma_f32 v[136:137], v[136:137], s[12:13], v[140:141]
    v_pk_fma_f32 v[138:139], v[138:139], s[12:13], v[140:141]
    v_pk_mul_f32 v[132:133], v[132:133], v[164:165]
    v_pk_mul_f32 v[134:135], v[134:135], v[166:167]
    v_pk_mul_f32 v[136:137], v[136:137], v[168:169]
    v_pk_mul_f32 v[138:139], v[138:139], v[170:171]
    v_exp_f32 v132, v132
    v_exp_f32 v133, v133
    v_exp_f32 v134, v134
    v_exp_f32 v135, v135
    v_exp_f32 v136, v136
    v_exp_f32 v137, v137
    v_exp_f32 v138, v138
    v_exp_f32 v139, v139
    v_pk_mul_f32 v[172:173], v[172:173], v[164:165]
    v_pk_mul_f32 v[174:175], v[174:175], v[166:167]
    v_pk_mul_f32 v[176:177], v[176:177], v[168:169]
    v_pk_mul_f32 v[178:179], v[178:179], v[170:171]
    v_pk_fma_f32 v[132:133], v[132:133], v[250:251], v[250:251] op_sel:[0,0,0] op_sel_hi:[1,0,0]
    v_pk_fma_f32 v[134:135], v[134:135], v[250:251], v[250:251] op_sel:[0,0,0] op_sel_hi:[1,0,0]
    v_pk_fma_f32 v[136:137], v[136:137], v[250:251], v[250:251] op_sel:[0,0,0] op_sel_hi:[1,0,0]
    v_pk_fma_f32 v[138:139], v[138:139], v[250:251], v[250:251] op_sel:[0,0,0] op_sel_hi:[1,0,0]
    v_rcp_f32 v132, v132
    v_rcp_f32 v133, v133
    v_rcp_f32 v134, v134
    v_rcp_f32 v135, v135
    v_rcp_f32 v136, v136
    v_rcp_f32 v137, v137
    v_rcp_f32 v138, v138
    v_rcp_f32 v139, v139
    s_nop 0
    v_pk_mul_f32 v[172:173], v[172:173], v[132:133]
    v_pk_mul_f32 v[174:175], v[174:175], v[134:135]
    v_pk_mul_f32 v[176:177], v[176:177], v[136:137]
    v_pk_mul_f32 v[178:179], v[178:179], v[138:139]
    v_cvt_pk_bf16_f32 v164, v172, v173
    v_cvt_pk_bf16_f32 v165, v174, v175
    v_cvt_pk_bf16_f32 v166, v176, v177
    v_cvt_pk_bf16_f32 v167, v178, v179
    buffer_store_dwordx4 v[164:167], v3, s[28:31], s14 offen offset:1024 sc1
    v_pk_mul_f32 v[132:133], v[212:213], v[212:213]
    v_pk_mul_f32 v[134:135], v[214:215], v[214:215]
    v_pk_mul_f32 v[136:137], v[216:217], v[216:217]
    v_pk_mul_f32 v[138:139], v[218:219], v[218:219]
    v_pk_fma_f32 v[132:133], v[132:133], s[12:13], v[140:141]
    v_pk_fma_f32 v[134:135], v[134:135], s[12:13], v[140:141]
    v_pk_fma_f32 v[136:137], v[136:137], s[12:13], v[140:141]
    v_pk_fma_f32 v[138:139], v[138:139], s[12:13], v[140:141]
    v_pk_mul_f32 v[132:133], v[132:133], v[212:213]
    v_pk_mul_f32 v[134:135], v[134:135], v[214:215]
    v_pk_mul_f32 v[136:137], v[136:137], v[216:217]
    v_pk_mul_f32 v[138:139], v[138:139], v[218:219]
    v_exp_f32 v132, v132
    v_exp_f32 v133, v133
    v_exp_f32 v134, v134
    v_exp_f32 v135, v135
    v_exp_f32 v136, v136
    v_exp_f32 v137, v137
    v_exp_f32 v138, v138
    v_exp_f32 v139, v139
    v_pk_mul_f32 v[220:221], v[220:221], v[212:213]
    v_pk_mul_f32 v[222:223], v[222:223], v[214:215]
    v_pk_mul_f32 v[224:225], v[224:225], v[216:217]
    v_pk_mul_f32 v[226:227], v[226:227], v[218:219]
    v_pk_fma_f32 v[132:133], v[132:133], v[250:251], v[250:251] op_sel:[0,1,1] op_sel_hi:[1,1,1]
    v_pk_fma_f32 v[134:135], v[134:135], v[250:251], v[250:251] op_sel:[0,1,1] op_sel_hi:[1,1,1]
    v_pk_fma_f32 v[136:137], v[136:137], v[250:251], v[250:251] op_sel:[0,1,1] op_sel_hi:[1,1,1]
    v_pk_fma_f32 v[138:139], v[138:139], v[250:251], v[250:251] op_sel:[0,1,1] op_sel_hi:[1,1,1]
    v_rcp_f32 v132, v132
    v_rcp_f32 v133, v133
    v_rcp_f32 v134, v134
    v_rcp_f32 v135, v135
    v_rcp_f32 v136, v136
    v_rcp_f32 v137, v137
    v_rcp_f32 v138, v138
    v_rcp_f32 v139, v139
    s_nop 0
    v_pk_mul_f32 v[220:221], v[220:221], v[132:133]
    v_pk_mul_f32 v[222:223], v[222:223], v[134:135]
    v_pk_mul_f32 v[224:225], v[224:225], v[136:137]
    v_pk_mul_f32 v[226:227], v[226:227], v[138:139]
    v_cvt_pk_bf16_f32 v212, v220, v221
    v_cvt_pk_bf16_f32 v213, v222, v223
    v_cvt_pk_bf16_f32 v214, v224, v225
    v_cvt_pk_bf16_f32 v215, v226, v227
    buffer_store_dwordx4 v[212:215], v3, s[28:31], s15 offen offset:1024 sc1
    v_pk_mul_f32 v[132:133], v[180:181], v[180:181]
    v_pk_mul_f32 v[134:135], v[182:183], v[182:183]
    v_pk_mul_f32 v[136:137], v[184:185], v[184:185]
    v_pk_mul_f32 v[138:139], v[186:187], v[186:187]
    v_pk_fma_f32 v[132:133], v[132:133], s[12:13], v[140:141]
    v_pk_fma_f32 v[134:135], v[134:135], s[12:13], v[140:141]
    v_pk_fma_f32 v[136:137], v[136:137], s[12:13], v[140:141]
    v_pk_fma_f32 v[138:139], v[138:139], s[12:13], v[140:141]
    v_pk_mul_f32 v[132:133], v[132:133], v[180:181]
    v_pk_mul_f32 v[134:135], v[134:135], v[182:183]
    v_pk_mul_f32 v[136:137], v[136:137], v[184:185]
    v_pk_mul_f32 v[138:139], v[138:139], v[186:187]
    v_exp_f32 v132, v132
    v_exp_f32 v133, v133
    v_exp_f32 v134, v134
    v_exp_f32 v135, v135
    v_exp_f32 v136, v136
    v_exp_f32 v137, v137
    v_exp_f32 v138, v138
    v_exp_f32 v139, v139
    v_pk_mul_f32 v[188:189], v[188:189], v[180:181]
    v_pk_mul_f32 v[190:191], v[190:191], v[182:183]
    v_pk_mul_f32 v[192:193], v[192:193], v[184:185]
    v_pk_mul_f32 v[194:195], v[194:195], v[186:187]
    v_pk_fma_f32 v[132:133], v[132:133], v[250:251], v[250:251] op_sel:[0,0,0] op_sel_hi:[1,0,0]
    v_pk_fma_f32 v[134:135], v[134:135], v[250:251], v[250:251] op_sel:[0,0,0] op_sel_hi:[1,0,0]
    v_pk_fma_f32 v[136:137], v[136:137], v[250:251], v[250:251] op_sel:[0,0,0] op_sel_hi:[1,0,0]
    v_pk_fma_f32 v[138:139], v[138:139], v[250:251], v[250:251] op_sel:[0,0,0] op_sel_hi:[1,0,0]
    v_rcp_f32 v132, v132
    v_rcp_f32 v133, v133
    v_rcp_f32 v134, v134
    v_rcp_f32 v135, v135
    v_rcp_f32 v136, v136
    v_rcp_f32 v137, v137
    v_rcp_f32 v138, v138
    v_rcp_f32 v139, v139
    s_nop 0
    v_pk_mul_f32 v[188:189], v[188:189], v[132:133]
    v_pk_mul_f32 v[190:191], v[190:191], v[134:135]
    v_pk_mul_f32 v[192:193], v[192:193], v[136:137]
    v_pk_mul_f32 v[194:195], v[194:195], v[138:139]
    v_cvt_pk_bf16_f32 v180, v188, v189
    v_cvt_pk_bf16_f32 v181, v190, v191
    v_cvt_pk_bf16_f32 v182, v192, v193
    v_cvt_pk_bf16_f32 v183, v194, v195
    buffer_store_dwordx4 v[180:183], v3, s[28:31], s14 offen offset:2048 sc1
    v_pk_mul_f32 v[132:133], v[228:229], v[228:229]
    v_pk_mul_f32 v[134:135], v[230:231], v[230:231]
    v_pk_mul_f32 v[136:137], v[232:233], v[232:233]
    v_pk_mul_f32 v[138:139], v[234:235], v[234:235]
    v_pk_fma_f32 v[132:133], v[132:133], s[12:13], v[140:141]
    v_pk_fma_f32 v[134:135], v[134:135], s[12:13], v[140:141]
    v_pk_fma_f32 v[136:137], v[136:137], s[12:13], v[140:141]
    v_pk_fma_f32 v[138:139], v[138:139], s[12:13], v[140:141]
    v_pk_mul_f32 v[132:133], v[132:133], v[228:229]
    v_pk_mul_f32 v[134:135], v[134:135], v[230:231]
    v_pk_mul_f32 v[136:137], v[136:137], v[232:233]
    v_pk_mul_f32 v[138:139], v[138:139], v[234:235]
    v_exp_f32 v132, v132
    v_exp_f32 v133, v133
    v_exp_f32 v134, v134
    v_exp_f32 v135, v135
    v_exp_f32 v136, v136
    v_exp_f32 v137, v137
    v_exp_f32 v138, v138
    v_exp_f32 v139, v139
    v_pk_mul_f32 v[236:237], v[236:237], v[228:229]
    v_pk_mul_f32 v[238:239], v[238:239], v[230:231]
    v_pk_mul_f32 v[240:241], v[240:241], v[232:233]
    v_pk_mul_f32 v[242:243], v[242:243], v[234:235]
    v_pk_fma_f32 v[132:133], v[132:133], v[250:251], v[250:251] op_sel:[0,1,1] op_sel_hi:[1,1,1]
    v_pk_fma_f32 v[134:135], v[134:135], v[250:251], v[250:251] op_sel:[0,1,1] op_sel_hi:[1,1,1]
    v_pk_fma_f32 v[136:137], v[136:137], v[250:251], v[250:251] op_sel:[0,1,1] op_sel_hi:[1,1,1]
    v_pk_fma_f32 v[138:139], v[138:139], v[250:251], v[250:251] op_sel:[0,1,1] op_sel_hi:[1,1,1]
    v_rcp_f32 v132, v132
    v_rcp_f32 v133, v133
    v_rcp_f32 v134, v134
    v_rcp_f32 v135, v135
    v_rcp_f32 v136, v136
    v_rcp_f32 v137, v137
    v_rcp_f32 v138, v138
    v_rcp_f32 v139, v139
    s_nop 0
    v_pk_mul_f32 v[236:237], v[236:237], v[132:133]
    v_pk_mul_f32 v[238:239], v[238:239], v[134:135]
    v_pk_mul_f32 v[240:241], v[240:241], v[136:137]
    v_pk_mul_f32 v[242:243], v[242:243], v[138:139]
    v_cvt_pk_bf16_f32 v228, v236, v237
    v_cvt_pk_bf16_f32 v229, v238, v239
    v_cvt_pk_bf16_f32 v230, v240, v241
    v_cvt_pk_bf16_f32 v231, v242, v243
    buffer_store_dwordx4 v[228:231], v3, s[28:31], s15 offen offset:2048 sc1
    s_lshl_b32 s13, s24, 1
    s_add_u32 s13, s13, s8
    s_lshl_b32 s13, s13, 4
    s_add_u32 s13, s13, s25
    s_lshl_b32 s13, s13, 1
    s_add_u32 s13, s13, s35
    s_lshl_b32 s13, s13, 7
    s_add_u32 s13, s13, 0x14b8000
    s_lshr_b32 s63, s6, 1
    s_lshl_b32 s63, s63, 3
    s_and_b32 s12, s7, 7
    s_add_u32 s63, s63, s12
    s_lshl_b32 s12, s63, 2
    s_add_u32 s12, s12, s36
    s_lshl_b32 s12, s12, 10
    v_and_b32 v212, 7, v1
    v_lshlrev_b32 v212, 7, v212
    v_add_u32 v212, s12, v212
    s_mov_b32 s39, 0x14b8000
    v_lshrrev_b32 v208, 4, v1
    v_and_b32 v209, 15, v1
    v_lshlrev_b32 v209, 4, v209
    v_lshl_add_u32 v208, v208, 9, v209
    s_mul_i32 s12, s36, 24576
    s_mul_i32 s14, s63, 196608
    s_add_u32 s12, s12, s14
    s_add_u32 s12, s12, 0x900000
    v_add_u32 v208, s12, v208
    v_add_u32 v209, 256, v208
    v_add_u32 v210, 98304, v208
    v_add_u32 v211, 98560, v208
    s_bfe_u32 s12, s7, 0x10003
    s_lshl_b32 s12, s12, 8
    s_bfe_u32 s14, s7, 0x10004
    s_mul_i32 s14, s14, 98304
    s_add_u32 s12, s12, s14
    v_add_u32 v8, s12, v208
    s_mul_i32 s57, s36, -16384
    s_add_u32 s57, s57, 98304
    s_add_u32 s58, s57, 4096
    s_mul_i32 s59, s36, -22528
    s_add_u32 s59, s59, 131072
    s_mul_i32 s12, s36, 30720
    s_add_u32 m0, s12, 23552
    s_barrier
    v_mfma_f32_32x32x16_bf16 v[56:71], v[88:91], v[20:23], 0
    buffer_load_dwordx4 a[200:203], v248, s[28:31], s17 offen offset:0 sc1
    v_exp_f32 v40, v40
    v_exp_f32 v41, v41
    v_exp_f32 v42, v42
    v_exp_f32 v43, v43
    v_cvt_pk_bf16_f32 v72, v40, v41
    v_mfma_f32_32x32x8_bf16 v[56:71], v[100:101], v[34:35], v[56:71]
    v_exp_f32 v44, v44
    v_exp_f32 v45, v45
    v_exp_f32 v46, v46
    v_exp_f32 v47, v47
    v_cvt_pk_bf16_f32 v73, v42, v43
    v_cvt_pk_bf16_f32 v74, v44, v45
    v_mfma_f32_32x32x16_bf16 a[48:63], v[124:127], v[80:83], a[48:63]
    buffer_load_dwordx4 a[64:67], v244, s[28:31], s16 offen offset:0 sc1
    v_exp_f32 v48, v48
    v_exp_f32 v49, v49
    v_exp_f32 v50, v50
    v_exp_f32 v51, v51
    v_cvt_pk_bf16_f32 v75, v46, v47
    v_cvt_pk_bf16_f32 v76, v48, v49
    v_mfma_f32_32x32x16_bf16 a[48:63], v[128:131], v[84:87], a[48:63]
    s_waitcnt vmcnt(31)
    buffer_load_dwordx4 a[68:71], v245, s[28:31], s16 offen offset:0 sc1
    v_exp_f32 v52, v52
    v_exp_f32 v53, v53
    v_exp_f32 v54, v54
    v_exp_f32 v55, v55
    v_cvt_pk_bf16_f32 v77, v50, v51
    v_cvt_pk_bf16_f32 v78, v52, v53
    v_cvt_pk_bf16_f32 v79, v54, v55
    v_mfma_f32_32x32x16_bf16 v[40:55], v[88:91], v[24:27], 0
    buffer_load_dwordx4 v[124:127], v4, s[44:47], 0 offen offset:2560
    v_exp_f32 v56, v56
    v_exp_f32 v57, v57
    v_exp_f32 v58, v58
    v_exp_f32 v59, v59
    v_cvt_pk_bf16_f32 v80, v56, v57
    v_mfma_f32_32x32x8_bf16 v[40:55], v[100:101], v[36:37], v[40:55]
    v_exp_f32 v60, v60
    v_exp_f32 v61, v61
    v_exp_f32 v62, v62
    v_exp_f32 v63, v63
    v_cvt_pk_bf16_f32 v81, v58, v59
    v_cvt_pk_bf16_f32 v82, v60, v61
    v_mfma_f32_32x32x16_bf16 a[0:15], v[108:111], v[72:75], a[0:15]
    buffer_load_dwordx4 v[128:131], v4, s[44:47], 0 offen offset:3200
    v_mad_i32_i24 v4, v5, s50, v4
    v_exp_f32 v64, v64
    v_exp_f32 v65, v65
    v_exp_f32 v66, v66
    v_exp_f32 v67, v67
    v_cvt_pk_bf16_f32 v83, v62, v63
    v_cvt_pk_bf16_f32 v84, v64, v65
    v_mfma_f32_32x32x16_bf16 a[0:15], v[112:115], v[76:79], a[0:15]
    buffer_load_dwordx4 a[72:75], v246, s[28:31], s16 offen offset:0 sc1
    v_exp_f32 v68, v68
    v_exp_f32 v69, v69
    v_exp_f32 v70, v70
    v_exp_f32 v71, v71
    v_cvt_pk_bf16_f32 v85, v66, v67
    v_cvt_pk_bf16_f32 v86, v68, v69
    v_cvt_pk_bf16_f32 v87, v70, v71
    v_mfma_f32_32x32x16_bf16 v[56:71], v[88:91], v[28:31], 0
    s_add_u32 s5, s5, 1
    s_mul_i32 s53, s52, -3840
    s_add_u32 s53, s53, 38400
    buffer_load_dwordx4 a[76:79], v247, s[28:31], s16 offen offset:0 sc1
    v_exp_f32 v40, v40
    v_exp_f32 v41, v41
    v_exp_f32 v42, v42
    v_exp_f32 v43, v43
    v_cvt_pk_bf16_f32 v72, v40, v41
    v_mfma_f32_32x32x8_bf16 v[56:71], v[100:101], v[38:39], v[56:71]
    v_exp_f32 v44, v44
    v_exp_f32 v45, v45
    v_exp_f32 v46, v46
    v_exp_f32 v47, v47
    v_cvt_pk_bf16_f32 v73, v42, v43
    v_cvt_pk_bf16_f32 v74, v44, v45
    v_mfma_f32_32x32x16_bf16 a[16:31], v[108:111], v[80:83], a[16:31]
    s_add_u32 s52, s52, 1
    s_cmp_eq_u32 s52, 10
    s_cselect_b32 s52, 0, s52
    s_cselect_b32 s50, s54, s55
    buffer_load_dwordx4 a[80:83], v248, s[28:31], s16 offen offset:0 sc1
    v_exp_f32 v48, v48
    v_exp_f32 v49, v49
    v_exp_f32 v50, v50
    v_exp_f32 v51, v51
    v_cvt_pk_bf16_f32 v75, v46, v47
    v_cvt_pk_bf16_f32 v76, v48, v49
    v_mfma_f32_32x32x16_bf16 a[16:31], v[112:115], v[84:87], a[16:31]
    s_waitcnt vmcnt(33)
    s_cmp_eq_u32 s5, 9
    s_cselect_b32 s50, s53, s50
    buffer_load_dwordx4 a[84:87], v244, s[28:31], s16 offen offset:2048 sc1
    v_exp_f32 v52, v52
    v_exp_f32 v53, v53
    v_exp_f32 v54, v54
    v_exp_f32 v55, v55
    v_cvt_pk_bf16_f32 v77, v50, v51
    v_cvt_pk_bf16_f32 v78, v52, v53
    v_cvt_pk_bf16_f32 v79, v54, v55
    v_mfma_f32_32x32x16_bf16 v[40:55], v[92:95], v[16:19], 0
    buffer_load_dwordx4 v[88:91], v106, s[40:43], 0 offen offset:0
    v_exp_f32 v56, v56
    v_exp_f32 v57, v57
    v_exp_f32 v58, v58
    v_exp_f32 v59, v59
    v_cvt_pk_bf16_f32 v80, v56, v57
    v_mfma_f32_32x32x8_bf16 v[40:55], v[102:103], v[32:33], v[40:55]
    v_exp_f32 v60, v60
    v_exp_f32 v61, v61
    v_exp_f32 v62, v62
    v_exp_f32 v63, v63
    v_cvt_pk_bf16_f32 v81, v58, v59
    v_cvt_pk_bf16_f32 v82, v60, v61
    v_mfma_f32_32x32x16_bf16 a[32:47], v[108:111], v[72:75], a[32:47]
    buffer_load_dwordx2 v[100:101], v107, s[40:43], 0 offen offset:1024
    v_exp_f32 v64, v64
    v_exp_f32 v65, v65
    v_exp_f32 v66, v66
    v_exp_f32 v67, v67
    v_cvt_pk_bf16_f32 v83, v62, v63
    v_cvt_pk_bf16_f32 v84, v64, v65
    v_mfma_f32_32x32x16_bf16 a[32:47], v[112:115], v[76:79], a[32:47]
    buffer_load_dwordx4 a[88:91], v245, s[28:31], s16 offen offset:2048 sc1
    v_exp_f32 v68, v68
    v_exp_f32 v69, v69
    v_exp_f32 v70, v70
    v_exp_f32 v71, v71
    v_cvt_pk_bf16_f32 v85, v66, v67
    v_cvt_pk_bf16_f32 v86, v68, v69
    v_cvt_pk_bf16_f32 v87, v70, v71
    v_mfma_f32_32x32x16_bf16 v[56:71], v[92:95], v[20:23], 0
    s_waitcnt vmcnt(12)
    buffer_store_dword v10, v249, s[28:31], s13 offen sc1
    v_exp_f32 v40, v40
    v_exp_f32 v41, v41
    v_exp_f32 v42, v42
    v_exp_f32 v43, v43
    v_cvt_pk_bf16_f32 v72, v40, v41
    v_mfma_f32_32x32x8_bf16 v[56:71], v[102:103], v[34:35], v[56:71]
    v_exp_f32 v44, v44
    v_exp_f32 v45, v45
    v_exp_f32 v46, v46
    v_exp_f32 v47, v47
    v_cvt_pk_bf16_f32 v73, v42, v43
    v_cvt_pk_bf16_f32 v74, v44, v45
    v_mfma_f32_32x32x16_bf16 a[48:63], v[108:111], v[80:83], a[48:63]
    buffer_load_dwordx4 a[92:95], v246, s[28:31], s16 offen offset:2048 sc1
    v_exp_f32 v48, v48
    v_exp_f32 v49, v49
    v_exp_f32 v50, v50
    v_exp_f32 v51, v51
    v_cvt_pk_bf16_f32 v75, v46, v47
    v_cvt_pk_bf16_f32 v76, v48, v49
    v_mfma_f32_32x32x16_bf16 a[48:63], v[112:115], v[84:87], a[48:63]
    s_waitcnt vmcnt(33)
    buffer_load_dwordx4 a[96:99], v247, s[28:31], s16 offen offset:2048 sc1
    v_exp_f32 v52, v52
    v_exp_f32 v53, v53
    v_exp_f32 v54, v54
    v_exp_f32 v55, v55
    v_cvt_pk_bf16_f32 v77, v50, v51
    v_cvt_pk_bf16_f32 v78, v52, v53
    v_cvt_pk_bf16_f32 v79, v54, v55
    v_mfma_f32_32x32x16_bf16 v[40:55], v[92:95], v[24:27], 0
    buffer_load_dwordx4 v[108:111], v4, s[44:47], 0 offen offset:0
    v_exp_f32 v56, v56
    v_exp_f32 v57, v57
    v_exp_f32 v58, v58
    v_exp_f32 v59, v59
    v_cvt_pk_bf16_f32 v80, v56, v57
    v_mfma_f32_32x32x8_bf16 v[40:55], v[102:103], v[36:37], v[40:55]
    v_exp_f32 v60, v60
    v_exp_f32 v61, v61
    v_exp_f32 v62, v62
    v_exp_f32 v63, v63
    v_cvt_pk_bf16_f32 v81, v58, v59
    v_cvt_pk_bf16_f32 v82, v60, v61
    v_mfma_f32_32x32x16_bf16 a[0:15], v[116:119], v[72:75], a[0:15]
    buffer_load_dwordx4 v[112:115], v4, s[44:47], 0 offen offset:640
    v_exp_f32 v64, v64
    v_exp_f32 v65, v65
    v_exp_f32 v66, v66
    v_exp_f32 v67, v67
    v_cvt_pk_bf16_f32 v83, v62, v63
    v_cvt_pk_bf16_f32 v84, v64, v65
    v_mfma_f32_32x32x16_bf16 a[0:15], v[120:123], v[76:79], a[0:15]
    buffer_load_dwordx4 a[100:103], v248, s[28:31], s16 offen offset:2048 sc1
    v_exp_f32 v68, v68
    v_exp_f32 v69, v69
    v_exp_f32 v70, v70
    v_exp_f32 v71, v71
    v_cvt_pk_bf16_f32 v85, v66, v67
    v_cvt_pk_bf16_f32 v86, v68, v69
    v_cvt_pk_bf16_f32 v87, v70, v71
    v_mfma_f32_32x32x16_bf16 v[56:71], v[92:95], v[28:31], 0
    buffer_load_dwordx4 a[204:207], v244, s[28:31], s17 offen offset:2048 sc1
    v_exp_f32 v40, v40
    v_exp_f32 v41, v41
    v_exp_f32 v42, v42
    v_exp_f32 v43, v43
    v_cvt_pk_bf16_f32 v72, v40, v41
    v_mfma_f32_32x32x8_bf16 v[56:71], v[102:103], v[38:39], v[56:71]
    v_exp_f32 v44, v44
    v_exp_f32 v45, v45
    v_exp_f32 v46, v46
    v_exp_f32 v47, v47
    v_cvt_pk_bf16_f32 v73, v42, v43
    v_cvt_pk_bf16_f32 v74, v44, v45
    v_mfma_f32_32x32x16_bf16 a[16:31], v[116:119], v[80:83], a[16:31]
    buffer_load_dwordx4 a[208:211], v245, s[28:31], s17 offen offset:2048 sc1
    v_exp_f32 v48, v48
    v_exp_f32 v49, v49
    v_exp_f32 v50, v50
    v_exp_f32 v51, v51
    v_cvt_pk_bf16_f32 v75, v46, v47
    v_cvt_pk_bf16_f32 v76, v48, v49
    v_mfma_f32_32x32x16_bf16 a[16:31], v[120:123], v[84:87], a[16:31]
    s_waitcnt vmcnt(29)
    buffer_load_dwordx4 a[212:215], v246, s[28:31], s17 offen offset:2048 sc1
    v_exp_f32 v52, v52
    v_exp_f32 v53, v53
    v_exp_f32 v54, v54
    v_exp_f32 v55, v55
    v_cvt_pk_bf16_f32 v77, v50, v51
    v_cvt_pk_bf16_f32 v78, v52, v53
    v_cvt_pk_bf16_f32 v79, v54, v55
    v_mfma_f32_32x32x16_bf16 v[40:55], v[96:99], v[16:19], 0
    buffer_load_dwordx4 v[92:95], v106, s[40:43], 0 offen offset:1280
    v_exp_f32 v56, v56
    v_exp_f32 v57, v57
    v_exp_f32 v58, v58
    v_exp_f32 v59, v59
    v_cvt_pk_bf16_f32 v80, v56, v57
    v_mfma_f32_32x32x8_bf16 v[40:55], v[104:105], v[32:33], v[40:55]
    v_exp_f32 v60, v60
    v_exp_f32 v61, v61
    v_exp_f32 v62, v62
    v_exp_f32 v63, v63
    v_cvt_pk_bf16_f32 v81, v58, v59
    v_cvt_pk_bf16_f32 v82, v60, v61
    v_mfma_f32_32x32x16_bf16 a[32:47], v[116:119], v[72:75], a[32:47]
    buffer_load_dwordx2 v[102:103], v107, s[40:43], 0 offen offset:2304
    v_exp_f32 v64, v64
    v_exp_f32 v65, v65
    v_exp_f32 v66, v66
    v_exp_f32 v67, v67
    v_cvt_pk_bf16_f32 v83, v62, v63
    v_cvt_pk_bf16_f32 v84, v64, v65
    v_mfma_f32_32x32x16_bf16 a[32:47], v[120:123], v[76:79], a[32:47]
    buffer_load_dwordx4 a[216:219], v247, s[28:31], s17 offen offset:2048 sc1
    v_exp_f32 v68, v68
    v_exp_f32 v69, v69
    v_exp_f32 v70, v70
    v_exp_f32 v71, v71
    v_cvt_pk_bf16_f32 v85, v66, v67
    v_cvt_pk_bf16_f32 v86, v68, v69
    v_cvt_pk_bf16_f32 v87, v70, v71
    v_mfma_f32_32x32x16_bf16 v[56:71], v[96:99], v[20:23], 0
    buffer_load_dwordx4 a[220:223], v248, s[28:31], s17 offen offset:2048 sc1
    v_exp_f32 v40, v40
    v_exp_f32 v41, v41
    v_exp_f32 v42, v42
    v_exp_f32 v43, v43
    v_cvt_pk_bf16_f32 v72, v40, v41
    v_mfma_f32_32x32x8_bf16 v[56:71], v[104:105], v[34:35], v[56:71]
    v_exp_f32 v44, v44
    v_exp_f32 v45, v45
    v_exp_f32 v46, v46
    v_exp_f32 v47, v47
    v_cvt_pk_bf16_f32 v73, v42, v43
    v_cvt_pk_bf16_f32 v74, v44, v45
    v_mfma_f32_32x32x16_bf16 a[48:63], v[116:119], v[80:83], a[48:63]
    buffer_load_dwordx4 a[224:227], v244, s[28:31], s9 offen offset:0 sc1
    v_exp_f32 v48, v48
    v_exp_f32 v49, v49
    v_exp_f32 v50, v50
    v_exp_f32 v51, v51
    v_cvt_pk_bf16_f32 v75, v46, v47
    v_cvt_pk_bf16_f32 v76, v48, v49
    v_mfma_f32_32x32x16_bf16 a[48:63], v[120:123], v[84:87], a[48:63]
    s_waitcnt vmcnt(21)
    buffer_load_dwordx4 a[228:231], v245, s[28:31], s9 offen offset:0 sc1
    v_exp_f32 v52, v52
    v_exp_f32 v53, v53
    v_exp_f32 v54, v54
    v_exp_f32 v55, v55
    v_cvt_pk_bf16_f32 v77, v50, v51
    v_cvt_pk_bf16_f32 v78, v52, v53
    v_cvt_pk_bf16_f32 v79, v54, v55
    v_mfma_f32_32x32x16_bf16 v[40:55], v[96:99], v[24:27], 0
    buffer_load_dwordx4 v[116:119], v4, s[44:47], 0 offen offset:1280
    v_exp_f32 v56, v56
    v_exp_f32 v57, v57
    v_exp_f32 v58, v58
    v_exp_f32 v59, v59
    v_cvt_pk_bf16_f32 v80, v56, v57
    v_mfma_f32_32x32x8_bf16 v[40:55], v[104:105], v[36:37], v[40:55]
    v_exp_f32 v60, v60
    v_exp_f32 v61, v61
    v_exp_f32 v62, v62
    v_exp_f32 v63, v63
    v_cvt_pk_bf16_f32 v81, v58, v59
    v_cvt_pk_bf16_f32 v82, v60, v61
    v_mfma_f32_32x32x16_bf16 a[0:15], v[124:127], v[72:75], a[0:15]
    buffer_load_dwordx4 v[120:123], v4, s[44:47], 0 offen offset:1920
    v_exp_f32 v64, v64
    v_exp_f32 v65, v65
    v_exp_f32 v66, v66
    v_exp_f32 v67, v67
    v_cvt_pk_bf16_f32 v83, v62, v63
    v_cvt_pk_bf16_f32 v84, v64, v65
    v_mfma_f32_32x32x16_bf16 a[0:15], v[128:131], v[76:79], a[0:15]
    buffer_load_dwordx4 a[232:235], v246, s[28:31], s9 offen offset:0 sc1
    v_exp_f32 v68, v68
    v_exp_f32 v69, v69
    v_exp_f32 v70, v70
    v_exp_f32 v71, v71
    v_cvt_pk_bf16_f32 v85, v66, v67
    v_cvt_pk_bf16_f32 v86, v68, v69
    v_cvt_pk_bf16_f32 v87, v70, v71
    v_mfma_f32_32x32x16_bf16 v[56:71], v[96:99], v[28:31], 0
    buffer_load_dwordx4 a[236:239], v247, s[28:31], s9 offen offset:0 sc1
    v_exp_f32 v40, v40
    v_exp_f32 v41, v41
    v_exp_f32 v42, v42
    v_exp_f32 v43, v43
    v_cvt_pk_bf16_f32 v72, v40, v41
    v_mfma_f32_32x32x8_bf16 v[56:71], v[104:105], v[38:39], v[56:71]
    v_exp_f32 v44, v44
    v_exp_f32 v45, v45
    v_exp_f32 v46, v46
    v_exp_f32 v47, v47
    v_cvt_pk_bf16_f32 v73, v42, v43
    v_cvt_pk_bf16_f32 v74, v44, v45
    v_mfma_f32_32x32x16_bf16 a[16:31], v[124:127], v[80:83], a[16:31]
    buffer_load_dwordx4 a[240:243], v248, s[28:31], s9 offen offset:0 sc1
    v_exp_f32 v48, v48
    v_exp_f32 v49, v49
    v_exp_f32 v50, v50
    v_exp_f32 v51, v51
    v_cvt_pk_bf16_f32 v75, v46, v47
    v_cvt_pk_bf16_f32 v76, v48, v49
    v_mfma_f32_32x32x16_bf16 a[16:31], v[128:131], v[84:87], a[16:31]
    s_waitcnt vmcnt(21)
    buffer_load_dwordx4 v[144:147], v244, s[28:31], s9 offen offset:2048 sc1
    v_exp_f32 v52, v52
    v_exp_f32 v53, v53
    v_exp_f32 v54, v54
    v_exp_f32 v55, v55
    v_cvt_pk_bf16_f32 v77, v50, v51
    v_cvt_pk_bf16_f32 v78, v52, v53
    v_cvt_pk_bf16_f32 v79, v54, v55
    v_mfma_f32_32x32x16_bf16 v[40:55], v[88:91], v[16:19], 0
    buffer_load_dwordx4 v[96:99], v106, s[40:43], 0 offen offset:2560
    v_exp_f32 v56, v56
    v_exp_f32 v57, v57
    v_exp_f32 v58, v58
    v_exp_f32 v59, v59
    v_cvt_pk_bf16_f32 v80, v56, v57
    v_mfma_f32_32x32x8_bf16 v[40:55], v[100:101], v[32:33], v[40:55]
    v_exp_f32 v60, v60
    v_exp_f32 v61, v61
    v_exp_f32 v62, v62
    v_exp_f32 v63, v63
    v_cvt_pk_bf16_f32 v81, v58, v59
    v_cvt_pk_bf16_f32 v82, v60, v61
    v_mfma_f32_32x32x16_bf16 a[32:47], v[124:127], v[72:75], a[32:47]
    buffer_load_dwordx2 v[104:105], v107, s[40:43], 0 offen offset:3584
    v_add_u32 v106, s50, v106
    v_add_u32 v107, s50, v107
    v_exp_f32 v64, v64
    v_exp_f32 v65, v65
    v_exp_f32 v66, v66
    v_exp_f32 v67, v67
    v_cvt_pk_bf16_f32 v83, v62, v63
    v_cvt_pk_bf16_f32 v84, v64, v65
    v_mfma_f32_32x32x16_bf16 a[32:47], v[128:131], v[76:79], a[32:47]
    buffer_load_dwordx4 v[148:151], v245, s[28:31], s9 offen offset:2048 sc1
    v_exp_f32 v68, v68
    v_exp_f32 v69, v69
    v_exp_f32 v70, v70
    v_exp_f32 v71, v71
    v_cvt_pk_bf16_f32 v85, v66, v67
    v_cvt_pk_bf16_f32 v86, v68, v69
    v_cvt_pk_bf16_f32 v87, v70, v71
    v_mfma_f32_32x32x16_bf16 v[56:71], v[88:91], v[20:23], 0
    buffer_load_dwordx4 v[152:155], v246, s[28:31], s9 offen offset:2048 sc1
    v_exp_f32 v40, v40
    v_exp_f32 v41, v41
    v_exp_f32 v42, v42
    v_exp_f32 v43, v43
    v_cvt_pk_bf16_f32 v72, v40, v41
    v_mfma_f32_32x32x8_bf16 v[56:71], v[100:101], v[34:35], v[56:71]
    v_exp_f32 v44, v44
    v_exp_f32 v45, v45
    v_exp_f32 v46, v46
    v_exp_f32 v47, v47
    v_cvt_pk_bf16_f32 v73, v42, v43
    v_cvt_pk_bf16_f32 v74, v44, v45
    v_mfma_f32_32x32x16_bf16 a[48:63], v[124:127], v[80:83], a[48:63]
    buffer_load_dwordx4 v[156:159], v247, s[28:31], s9 offen offset:2048 sc1
    v_exp_f32 v48, v48
    v_exp_f32 v49, v49
    v_exp_f32 v50, v50
    v_exp_f32 v51, v51
    v_cvt_pk_bf16_f32 v75, v46, v47
    v_cvt_pk_bf16_f32 v76, v48, v49
    v_mfma_f32_32x32x16_bf16 a[48:63], v[128:131], v[84:87], a[48:63]
    s_waitcnt vmcnt(21)
    buffer_load_dwordx4 v[160:163], v248, s[28:31], s9 offen offset:2048 sc1
    v_exp_f32 v52, v52
    v_exp_f32 v53, v53
    v_exp_f32 v54, v54
    v_exp_f32 v55, v55
    v_cvt_pk_bf16_f32 v77, v50, v51
    v_cvt_pk_bf16_f32 v78, v52, v53
    v_cvt_pk_bf16_f32 v79, v54, v55
    v_mfma_f32_32x32x16_bf16 v[40:55], v[88:91], v[24:27], 0
    buffer_load_dwordx4 v[124:127], v4, s[44:47], 0 offen offset:2560
    v_exp_f32 v56, v56
    v_exp_f32 v57, v57
    v_exp_f32 v58, v58
    v_exp_f32 v59, v59
    v_cvt_pk_bf16_f32 v80, v56, v57
    v_mfma_f32_32x32x8_bf16 v[40:55], v[100:101], v[36:37], v[40:55]
    v_exp_f32 v60, v60
    v_exp_f32 v61, v61
    v_exp_f32 v62, v62
    v_exp_f32 v63, v63
    v_cvt_pk_bf16_f32 v81, v58, v59
    v_cvt_pk_bf16_f32 v82, v60, v61
    v_mfma_f32_32x32x16_bf16 a[0:15], v[108:111], v[72:75], a[0:15]
    buffer_load_dwordx4 v[128:131], v4, s[44:47], 0 offen offset:3200
    v_mad_i32_i24 v4, v5, s50, v4
    v_exp_f32 v64, v64
    v_exp_f32 v65, v65
    v_exp_f32 v66, v66
    v_exp_f32 v67, v67
    v_cvt_pk_bf16_f32 v83, v62, v63
    v_cvt_pk_bf16_f32 v84, v64, v65
    v_mfma_f32_32x32x16_bf16 a[0:15], v[112:115], v[76:79], a[0:15]
    buffer_load_dwordx4 v[164:167], v244, s[28:31], s56 offen offset:0 sc1
    v_exp_f32 v68, v68
    v_exp_f32 v69, v69
    v_exp_f32 v70, v70
    v_exp_f32 v71, v71
    v_cvt_pk_bf16_f32 v85, v66, v67
    v_cvt_pk_bf16_f32 v86, v68, v69
    v_cvt_pk_bf16_f32 v87, v70, v71
    v_mfma_f32_32x32x16_bf16 v[56:71], v[88:91], v[28:31], 0
    buffer_load_dwordx4 v[168:171], v245, s[28:31], s56 offen offset:0 sc1
    v_exp_f32 v40, v40
    v_exp_f32 v41, v41
    v_exp_f32 v42, v42
    v_exp_f32 v43, v43
    v_cvt_pk_bf16_f32 v72, v40, v41
    v_mfma_f32_32x32x8_bf16 v[56:71], v[100:101], v[38:39], v[56:71]
    v_exp_f32 v44, v44
    v_exp_f32 v45, v45
    v_exp_f32 v46, v46
    v_exp_f32 v47, v47
    v_cvt_pk_bf16_f32 v73, v42, v43
    v_cvt_pk_bf16_f32 v74, v44, v45
    v_mfma_f32_32x32x16_bf16 a[16:31], v[108:111], v[80:83], a[16:31]
    buffer_load_dwordx4 v[172:175], v246, s[28:31], s56 offen offset:0 sc1
    v_exp_f32 v48, v48
    v_exp_f32 v49, v49
    v_exp_f32 v50, v50
    v_exp_f32 v51, v51
    v_cvt_pk_bf16_f32 v75, v46, v47
    v_cvt_pk_bf16_f32 v76, v48, v49
    v_mfma_f32_32x32x16_bf16 a[16:31], v[112:115], v[84:87], a[16:31]
    s_waitcnt vmcnt(21)
    buffer_load_dwordx4 v[176:179], v247, s[28:31], s56 offen offset:0 sc1
    v_exp_f32 v52, v52
    v_exp_f32 v53, v53
    v_exp_f32 v54, v54
    v_exp_f32 v55, v55
    v_cvt_pk_bf16_f32 v77, v50, v51
    v_cvt_pk_bf16_f32 v78, v52, v53
    v_cvt_pk_bf16_f32 v79, v54, v55
    v_mfma_f32_32x32x16_bf16 v[40:55], v[92:95], v[16:19], 0
    buffer_load_dwordx4 v[88:91], v106, s[40:43], 0 offen offset:0
    v_exp_f32 v56, v56
    v_exp_f32 v57, v57
    v_exp_f32 v58, v58
    v_exp_f32 v59, v59
    v_cvt_pk_bf16_f32 v80, v56, v57
    v_mfma_f32_32x32x8_bf16 v[40:55], v[102:103], v[32:33], v[40:55]
    v_exp_f32 v60, v60
    v_exp_f32 v61, v61
    v_exp_f32 v62, v62
    v_exp_f32 v63, v63
    v_cvt_pk_bf16_f32 v81, v58, v59
    v_cvt_pk_bf16_f32 v82, v60, v61
    v_mfma_f32_32x32x16_bf16 a[32:47], v[108:111], v[72:75], a[32:47]
    buffer_load_dwordx2 v[100:101], v107, s[40:43], 0 offen offset:1024
    v_exp_f32 v64, v64
    v_exp_f32 v65, v65
    v_exp_f32 v66, v66
    v_exp_f32 v67, v67
    v_cvt_pk_bf16_f32 v83, v62, v63
    v_cvt_pk_bf16_f32 v84, v64, v65
    v_mfma_f32_32x32x16_bf16 a[32:47], v[112:115], v[76:79], a[32:47]
    buffer_load_dwordx4 v[180:183], v248, s[28:31], s56 offen offset:0 sc1
    v_exp_f32 v68, v68
    v_exp_f32 v69, v69
    v_exp_f32 v70, v70
    v_exp_f32 v71, v71
    v_cvt_pk_bf16_f32 v85, v66, v67
    v_cvt_pk_bf16_f32 v86, v68, v69
    v_cvt_pk_bf16_f32 v87, v70, v71
    v_mfma_f32_32x32x16_bf16 v[56:71], v[92:95], v[20:23], 0
    buffer_load_dwordx4 v[184:187], v244, s[28:31], s56 offen offset:2048 sc1
    v_exp_f32 v40, v40
    v_exp_f32 v41, v41
    v_exp_f32 v42, v42
    v_exp_f32 v43, v43
    v_cvt_pk_bf16_f32 v72, v40, v41
    v_mfma_f32_32x32x8_bf16 v[56:71], v[102:103], v[34:35], v[56:71]
    v_exp_f32 v44, v44
    v_exp_f32 v45, v45
    v_exp_f32 v46, v46
    v_exp_f32 v47, v47
    v_cvt_pk_bf16_f32 v73, v42, v43
    v_cvt_pk_bf16_f32 v74, v44, v45
    v_mfma_f32_32x32x16_bf16 a[48:63], v[108:111], v[80:83], a[48:63]
    buffer_load_dwordx4 v[188:191], v245, s[28:31], s56 offen offset:2048 sc1
    v_exp_f32 v48, v48
    v_exp_f32 v49, v49
    v_exp_f32 v50, v50
    v_exp_f32 v51, v51
    v_cvt_pk_bf16_f32 v75, v46, v47
    v_cvt_pk_bf16_f32 v76, v48, v49
    v_mfma_f32_32x32x16_bf16 a[48:63], v[112:115], v[84:87], a[48:63]
    s_waitcnt vmcnt(21)
    buffer_load_dwordx4 v[192:195], v246, s[28:31], s56 offen offset:2048 sc1
    v_exp_f32 v52, v52
    v_exp_f32 v53, v53
    v_exp_f32 v54, v54
    v_exp_f32 v55, v55
    v_cvt_pk_bf16_f32 v77, v50, v51
    v_cvt_pk_bf16_f32 v78, v52, v53
    v_cvt_pk_bf16_f32 v79, v54, v55
    v_mfma_f32_32x32x16_bf16 v[40:55], v[92:95], v[24:27], 0
    buffer_load_dwordx4 v[108:111], v4, s[44:47], 0 offen offset:0
    v_exp_f32 v56, v56
    v_exp_f32 v57, v57
    v_exp_f32 v58, v58
    v_exp_f32 v59, v59
    v_cvt_pk_bf16_f32 v80, v56, v57
    v_mfma_f32_32x32x8_bf16 v[40:55], v[102:103], v[36:37], v[40:55]
    v_exp_f32 v60, v60
    v_exp_f32 v61, v61
    v_exp_f32 v62, v62
    v_exp_f32 v63, v63
    v_cvt_pk_bf16_f32 v81, v58, v59
    v_cvt_pk_bf16_f32 v82, v60, v61
    v_mfma_f32_32x32x16_bf16 a[0:15], v[116:119], v[72:75], a[0:15]
    buffer_load_dwordx4 v[112:115], v4, s[44:47], 0 offen offset:640
    v_exp_f32 v64, v64
    v_exp_f32 v65, v65
    v_exp_f32 v66, v66
    v_exp_f32 v67, v67
    v_cvt_pk_bf16_f32 v83, v62, v63
    v_cvt_pk_bf16_f32 v84, v64, v65
    v_mfma_f32_32x32x16_bf16 a[0:15], v[120:123], v[76:79], a[0:15]
    buffer_load_dwordx4 v[196:199], v247, s[28:31], s56 offen offset:2048 sc1
    v_exp_f32 v68, v68
    v_exp_f32 v69, v69
    v_exp_f32 v70, v70
    v_exp_f32 v71, v71
    v_cvt_pk_bf16_f32 v85, v66, v67
    v_cvt_pk_bf16_f32 v86, v68, v69
    v_cvt_pk_bf16_f32 v87, v70, v71
    v_mfma_f32_32x32x16_bf16 v[56:71], v[92:95], v[28:31], 0
    s_add_u32 m0, m0, 0x400
    buffer_load_dwordx4 v[200:203], v248, s[28:31], s56 offen offset:2048 sc1
    v_exp_f32 v40, v40
    v_exp_f32 v41, v41
    v_exp_f32 v42, v42
    v_exp_f32 v43, v43
    v_cvt_pk_bf16_f32 v72, v40, v41
    v_mfma_f32_32x32x8_bf16 v[56:71], v[102:103], v[38:39], v[56:71]
    v_exp_f32 v44, v44
    v_exp_f32 v45, v45
    v_exp_f32 v46, v46
    v_exp_f32 v47, v47
    v_cvt_pk_bf16_f32 v73, v42, v43
    v_cvt_pk_bf16_f32 v74, v44, v45
    v_mfma_f32_32x32x16_bf16 a[16:31], v[116:119], v[80:83], a[16:31]
    buffer_load_dwordx4 v244, s[28:31], s57 offen offset:0 sc1 lds
    s_add_u32 m0, m0, 0x400
    v_exp_f32 v48, v48
    v_exp_f32 v49, v49
    v_exp_f32 v50, v50
    v_exp_f32 v51, v51
    v_cvt_pk_bf16_f32 v75, v46, v47
    v_cvt_pk_bf16_f32 v76, v48, v49
    v_mfma_f32_32x32x16_bf16 a[16:31], v[120:123], v[84:87], a[16:31]
    s_waitcnt vmcnt(21)
    buffer_load_dwordx4 v245, s[28:31], s57 offen offset:0 sc1 lds
    v_exp_f32 v52, v52
    v_exp_f32 v53, v53
    v_exp_f32 v54, v54
    v_exp_f32 v55, v55
    v_cvt_pk_bf16_f32 v77, v50, v51
    v_cvt_pk_bf16_f32 v78, v52, v53
    v_cvt_pk_bf16_f32 v79, v54, v55
    v_mfma_f32_32x32x16_bf16 v[40:55], v[96:99], v[16:19], 0
    buffer_load_dwordx4 v[92:95], v106, s[40:43], 0 offen offset:1280
    v_exp_f32 v56, v56
    v_exp_f32 v57, v57
    v_exp_f32 v58, v58
    v_exp_f32 v59, v59
    v_cvt_pk_bf16_f32 v80, v56, v57
    v_mfma_f32_32x32x8_bf16 v[40:55], v[104:105], v[32:33], v[40:55]
    v_exp_f32 v60, v60
    v_exp_f32 v61, v61
    v_exp_f32 v62, v62
    v_exp_f32 v63, v63
    v_cvt_pk_bf16_f32 v81, v58, v59
    v_cvt_pk_bf16_f32 v82, v60, v61
    v_mfma_f32_32x32x16_bf16 a[32:47], v[116:119], v[72:75], a[32:47]
    s_add_u32 m0, m0, 0x400
    buffer_load_dwordx2 v[102:103], v107, s[40:43], 0 offen offset:2304
    v_exp_f32 v64, v64
    v_exp_f32 v65, v65
    v_exp_f32 v66, v66
    v_exp_f32 v67, v67
    v_cvt_pk_bf16_f32 v83, v62, v63
    v_cvt_pk_bf16_f32 v84, v64, v65
    v_mfma_f32_32x32x16_bf16 a[32:47], v[120:123], v[76:79], a[32:47]
    buffer_load_dwordx4 v246, s[28:31], s57 offen offset:0 sc1 lds
    s_add_u32 m0, m0, 0x400
    v_exp_f32 v68, v68
    v_exp_f32 v69, v69
    v_exp_f32 v70, v70
    v_exp_f32 v71, v71
    v_cvt_pk_bf16_f32 v85, v66, v67
    v_cvt_pk_bf16_f32 v86, v68, v69
    v_cvt_pk_bf16_f32 v87, v70, v71
    v_mfma_f32_32x32x16_bf16 v[56:71], v[96:99], v[20:23], 0
    buffer_load_dwordx4 v247, s[28:31], s57 offen offset:0 sc1 lds
    s_add_u32 m0, m0, 0x400
    v_exp_f32 v40, v40
    v_exp_f32 v41, v41
    v_exp_f32 v42, v42
    v_exp_f32 v43, v43
    v_cvt_pk_bf16_f32 v72, v40, v41
    v_mfma_f32_32x32x8_bf16 v[56:71], v[104:105], v[34:35], v[56:71]
    v_exp_f32 v44, v44
    v_exp_f32 v45, v45
    v_exp_f32 v46, v46
    v_exp_f32 v47, v47
    v_cvt_pk_bf16_f32 v73, v42, v43
    v_cvt_pk_bf16_f32 v74, v44, v45
    v_mfma_f32_32x32x16_bf16 a[48:63], v[116:119], v[80:83], a[48:63]
    buffer_load_dwordx4 v248, s[28:31], s57 offen offset:0 sc1 lds
    s_add_u32 m0, m0, 0xfffffc00
    v_exp_f32 v48, v48
    v_exp_f32 v49, v49
    v_exp_f32 v50, v50
    v_exp_f32 v51, v51
    v_cvt_pk_bf16_f32 v75, v46, v47
    v_cvt_pk_bf16_f32 v76, v48, v49
    v_mfma_f32_32x32x16_bf16 a[48:63], v[120:123], v[84:87], a[48:63]
    s_waitcnt vmcnt(21)
    buffer_load_dwordx4 v244, s[28:31], s57 offen offset:2048 sc1 lds
    v_exp_f32 v52, v52
    v_exp_f32 v53, v53
    v_exp_f32 v54, v54
    v_exp_f32 v55, v55
    v_cvt_pk_bf16_f32 v77, v50, v51
    v_cvt_pk_bf16_f32 v78, v52, v53
    v_cvt_pk_bf16_f32 v79, v54, v55
    v_mfma_f32_32x32x16_bf16 v[40:55], v[96:99], v[24:27], 0
    buffer_load_dwordx4 v[116:119], v4, s[44:47], 0 offen offset:1280
    v_exp_f32 v56, v56
    v_exp_f32 v57, v57
    v_exp_f32 v58, v58
    v_exp_f32 v59, v59
    v_cvt_pk_bf16_f32 v80, v56, v57
    v_mfma_f32_32x32x8_bf16 v[40:55], v[104:105], v[36:37], v[40:55]
    v_exp_f32 v60, v60
    v_exp_f32 v61, v61
    v_exp_f32 v62, v62
    v_exp_f32 v63, v63
    v_cvt_pk_bf16_f32 v81, v58, v59
    v_cvt_pk_bf16_f32 v82, v60, v61
    v_mfma_f32_32x32x16_bf16 a[0:15], v[124:127], v[72:75], a[0:15]
    s_add_u32 m0, m0, 0x400
    buffer_load_dwordx4 v[120:123], v4, s[44:47], 0 offen offset:1920
    v_exp_f32 v64, v64
    v_exp_f32 v65, v65
    v_exp_f32 v66, v66
    v_exp_f32 v67, v67
    v_cvt_pk_bf16_f32 v83, v62, v63
    v_cvt_pk_bf16_f32 v84, v64, v65
    v_mfma_f32_32x32x16_bf16 a[0:15], v[128:131], v[76:79], a[0:15]
    buffer_load_dwordx4 v245, s[28:31], s57 offen offset:2048 sc1 lds
    s_add_u32 m0, m0, 0x400
    v_exp_f32 v68, v68
    v_exp_f32 v69, v69
    v_exp_f32 v70, v70
    v_exp_f32 v71, v71
    v_cvt_pk_bf16_f32 v85, v66, v67
    v_cvt_pk_bf16_f32 v86, v68, v69
    v_cvt_pk_bf16_f32 v87, v70, v71
    v_mfma_f32_32x32x16_bf16 v[56:71], v[96:99], v[28:31], 0
    buffer_load_dwordx4 v246, s[28:31], s57 offen offset:2048 sc1 lds
    s_add_u32 m0, m0, 0x400
    v_exp_f32 v40, v40
    v_exp_f32 v41, v41
    v_exp_f32 v42, v42
    v_exp_f32 v43, v43
    v_cvt_pk_bf16_f32 v72, v40, v41
    v_mfma_f32_32x32x8_bf16 v[56:71], v[104:105], v[38:39], v[56:71]
    v_exp_f32 v44, v44
    v_exp_f32 v45, v45
    v_exp_f32 v46, v46
    v_exp_f32 v47, v47
    v_cvt_pk_bf16_f32 v73, v42, v43
    v_cvt_pk_bf16_f32 v74, v44, v45
    v_mfma_f32_32x32x16_bf16 a[16:31], v[124:127], v[80:83], a[16:31]
    buffer_load_dwordx4 v247, s[28:31], s57 offen offset:2048 sc1 lds
    s_add_u32 m0, m0, 0x400
    v_exp_f32 v48, v48
    v_exp_f32 v49, v49
    v_exp_f32 v50, v50
    v_exp_f32 v51, v51
    v_cvt_pk_bf16_f32 v75, v46, v47
    v_cvt_pk_bf16_f32 v76, v48, v49
    v_mfma_f32_32x32x16_bf16 a[16:31], v[128:131], v[84:87], a[16:31]
    s_waitcnt vmcnt(21)
    buffer_load_dwordx4 v248, s[28:31], s57 offen offset:2048 sc1 lds
    s_add_u32 m0, m0, 0xc00
    v_exp_f32 v52, v52
    v_exp_f32 v53, v53
    v_exp_f32 v54, v54
    v_exp_f32 v55, v55
    v_cvt_pk_bf16_f32 v77, v50, v51
    v_cvt_pk_bf16_f32 v78, v52, v53
    v_cvt_pk_bf16_f32 v79, v54, v55
    v_mfma_f32_32x32x16_bf16 v[40:55], v[88:91], v[16:19], 0
    buffer_load_dwordx4 v244, s[28:31], s58 offen offset:0 sc1 lds
    s_add_u32 m0, m0, 0x400
    v_exp_f32 v56, v56
    v_exp_f32 v57, v57
    v_exp_f32 v58, v58
    v_exp_f32 v59, v59
    v_cvt_pk_bf16_f32 v80, v56, v57
    v_mfma_f32_32x32x8_bf16 v[40:55], v[100:101], v[32:33], v[40:55]
    v_exp_f32 v60, v60
    v_exp_f32 v61, v61
    v_exp_f32 v62, v62
    v_exp_f32 v63, v63
    v_cvt_pk_bf16_f32 v81, v58, v59
    v_cvt_pk_bf16_f32 v82, v60, v61
    v_mfma_f32_32x32x16_bf16 a[32:47], v[124:127], v[72:75], a[32:47]
    buffer_load_dwordx4 v245, s[28:31], s58 offen offset:0 sc1 lds
    s_add_u32 m0, m0, 0x400
    v_exp_f32 v64, v64
    v_exp_f32 v65, v65
    v_exp_f32 v66, v66
    v_exp_f32 v67, v67
    v_cvt_pk_bf16_f32 v83, v62, v63
    v_cvt_pk_bf16_f32 v84, v64, v65
    v_mfma_f32_32x32x16_bf16 a[32:47], v[128:131], v[76:79], a[32:47]
    buffer_load_dwordx4 v246, s[28:31], s58 offen offset:0 sc1 lds
    s_add_u32 m0, m0, 0x400
    v_exp_f32 v68, v68
    v_exp_f32 v69, v69
    v_exp_f32 v70, v70
    v_exp_f32 v71, v71
    v_cvt_pk_bf16_f32 v85, v66, v67
    v_cvt_pk_bf16_f32 v86, v68, v69
    v_cvt_pk_bf16_f32 v87, v70, v71
    v_mfma_f32_32x32x16_bf16 v[56:71], v[88:91], v[20:23], 0
    buffer_load_dwordx4 v247, s[28:31], s58 offen offset:0 sc1 lds
    s_add_u32 m0, m0, 0x400
    v_exp_f32 v40, v40
    v_exp_f32 v41, v41
    v_exp_f32 v42, v42
    v_exp_f32 v43, v43
    v_cvt_pk_bf16_f32 v72, v40, v41
    v_mfma_f32_32x32x8_bf16 v[56:71], v[100:101], v[34:35], v[56:71]
    v_exp_f32 v44, v44
    v_exp_f32 v45, v45
    v_exp_f32 v46, v46
    v_exp_f32 v47, v47
    v_cvt_pk_bf16_f32 v73, v42, v43
    v_cvt_pk_bf16_f32 v74, v44, v45
    v_mfma_f32_32x32x16_bf16 a[48:63], v[124:127], v[80:83], a[48:63]
    buffer_load_dwordx4 v248, s[28:31], s58 offen offset:0 sc1 lds
    s_add_u32 m0, m0, 0xfffffc00
    v_exp_f32 v48, v48
    v_exp_f32 v49, v49
    v_exp_f32 v50, v50
    v_exp_f32 v51, v51
    v_cvt_pk_bf16_f32 v75, v46, v47
    v_cvt_pk_bf16_f32 v76, v48, v49
    v_mfma_f32_32x32x16_bf16 a[48:63], v[128:131], v[84:87], a[48:63]
    s_waitcnt vmcnt(21)
    buffer_load_dwordx4 v244, s[28:31], s58 offen offset:2048 sc1 lds
    s_add_u32 m0, m0, 0x400
    v_exp_f32 v52, v52
    v_exp_f32 v53, v53
    v_exp_f32 v54, v54
    v_exp_f32 v55, v55
    v_cvt_pk_bf16_f32 v77, v50, v51
    v_cvt_pk_bf16_f32 v78, v52, v53
    v_cvt_pk_bf16_f32 v79, v54, v55
    v_mfma_f32_32x32x16_bf16 v[40:55], v[88:91], v[24:27], 0
    buffer_load_dwordx4 v245, s[28:31], s58 offen offset:2048 sc1 lds
    s_add_u32 m0, m0, 0x400
    v_exp_f32 v56, v56
    v_exp_f32 v57, v57
    v_exp_f32 v58, v58
    v_exp_f32 v59, v59
    v_cvt_pk_bf16_f32 v80, v56, v57
    v_mfma_f32_32x32x8_bf16 v[40:55], v[100:101], v[36:37], v[40:55]
    v_exp_f32 v60, v60
    v_exp_f32 v61, v61
    v_exp_f32 v62, v62
    v_exp_f32 v63, v63
    v_cvt_pk_bf16_f32 v81, v58, v59
    v_cvt_pk_bf16_f32 v82, v60, v61
    v_mfma_f32_32x32x16_bf16 a[0:15], v[108:111], v[72:75], a[0:15]
    buffer_load_dwordx4 v246, s[28:31], s58 offen offset:2048 sc1 lds
    v_exp_f32 v64, v64
    v_exp_f32 v65, v65
    v_exp_f32 v66, v66
    v_exp_f32 v67, v67
    v_cvt_pk_bf16_f32 v83, v62, v63
    v_cvt_pk_bf16_f32 v84, v64, v65
    v_mfma_f32_32x32x16_bf16 a[0:15], v[112:115], v[76:79], a[0:15]
    s_add_u32 m0, m0, 0x400
    v_exp_f32 v68, v68
    v_exp_f32 v69, v69
    v_exp_f32 v70, v70
    v_exp_f32 v71, v71
    v_cvt_pk_bf16_f32 v85, v66, v67
    v_cvt_pk_bf16_f32 v86, v68, v69
    v_cvt_pk_bf16_f32 v87, v70, v71
    v_mfma_f32_32x32x16_bf16 v[56:71], v[88:91], v[28:31], 0
    buffer_load_dwordx4 v247, s[28:31], s58 offen offset:2048 sc1 lds
    s_add_u32 m0, m0, 0x400
    v_exp_f32 v40, v40
    v_exp_f32 v41, v41
    v_exp_f32 v42, v42
    v_exp_f32 v43, v43
    v_cvt_pk_bf16_f32 v72, v40, v41
    v_mfma_f32_32x32x8_bf16 v[56:71], v[100:101], v[38:39], v[56:71]
    v_exp_f32 v44, v44
    v_exp_f32 v45, v45
    v_exp_f32 v46, v46
    v_exp_f32 v47, v47
    v_cvt_pk_bf16_f32 v73, v42, v43
    v_cvt_pk_bf16_f32 v74, v44, v45
    v_mfma_f32_32x32x16_bf16 a[16:31], v[108:111], v[80:83], a[16:31]
    buffer_load_dwordx4 v248, s[28:31], s58 offen offset:2048 sc1 lds
    v_exp_f32 v48, v48
    v_exp_f32 v49, v49
    v_exp_f32 v50, v50
    v_exp_f32 v51, v51
    v_cvt_pk_bf16_f32 v75, v46, v47
    v_cvt_pk_bf16_f32 v76, v48, v49
    v_mfma_f32_32x32x16_bf16 a[16:31], v[112:115], v[84:87], a[16:31]
    s_waitcnt vmcnt(20)
    s_add_u32 m0, m0, 0xc00
    v_exp_f32 v52, v52
    v_exp_f32 v53, v53
    v_exp_f32 v54, v54
    v_exp_f32 v55, v55
    v_cvt_pk_bf16_f32 v77, v50, v51
    v_cvt_pk_bf16_f32 v78, v52, v53
    v_cvt_pk_bf16_f32 v79, v54, v55
    v_mfma_f32_32x32x16_bf16 v[40:55], v[92:95], v[24:27], 0
    buffer_load_dwordx4 v244, s[28:31], s59 offen offset:0 sc1 lds
    s_add_u32 m0, m0, 0x400
    v_exp_f32 v56, v56
    v_exp_f32 v57, v57
    v_exp_f32 v58, v58
    v_exp_f32 v59, v59
    v_cvt_pk_bf16_f32 v80, v56, v57
    v_mfma_f32_32x32x8_bf16 v[40:55], v[102:103], v[36:37], v[40:55]
    v_exp_f32 v60, v60
    v_exp_f32 v61, v61
    v_exp_f32 v62, v62
    v_exp_f32 v63, v63
    v_cvt_pk_bf16_f32 v81, v58, v59
    v_cvt_pk_bf16_f32 v82, v60, v61
    v_mfma_f32_32x32x16_bf16 a[32:47], v[108:111], v[72:75], a[32:47]
    buffer_load_dwordx4 v245, s[28:31], s59 offen offset:0 sc1 lds
    v_exp_f32 v64, v64
    v_exp_f32 v65, v65
    v_exp_f32 v66, v66
    v_exp_f32 v67, v67
    v_cvt_pk_bf16_f32 v83, v62, v63
    v_cvt_pk_bf16_f32 v84, v64, v65
    v_mfma_f32_32x32x16_bf16 a[32:47], v[112:115], v[76:79], a[32:47]
    v_exp_f32 v68, v68
    v_exp_f32 v69, v69
    v_exp_f32 v70, v70
    v_exp_f32 v71, v71
    v_cvt_pk_bf16_f32 v85, v66, v67
    v_cvt_pk_bf16_f32 v86, v68, v69
    v_cvt_pk_bf16_f32 v87, v70, v71
    v_mfma_f32_32x32x16_bf16 v[56:71], v[92:95], v[28:31], 0
    s_add_u32 m0, m0, 0x400
    buffer_load_dword v213, v212, s[28:31], s39 offen sc1
    v_exp_f32 v40, v40
    v_exp_f32 v41, v41
    v_exp_f32 v42, v42
    v_exp_f32 v43, v43
    v_cvt_pk_bf16_f32 v72, v40, v41
    v_mfma_f32_32x32x8_bf16 v[56:71], v[102:103], v[38:39], v[56:71]
    v_exp_f32 v44, v44
    v_exp_f32 v45, v45
    v_exp_f32 v46, v46
    v_exp_f32 v47, v47
    v_cvt_pk_bf16_f32 v73, v42, v43
    v_cvt_pk_bf16_f32 v74, v44, v45
    v_mfma_f32_32x32x16_bf16 a[48:63], v[108:111], v[80:83], a[48:63]
    buffer_load_dwordx4 v246, s[28:31], s59 offen offset:0 sc1 lds
    s_add_u32 m0, m0, 0x400
    v_exp_f32 v48, v48
    v_exp_f32 v49, v49
    v_exp_f32 v50, v50
    v_exp_f32 v51, v51
    v_cvt_pk_bf16_f32 v75, v46, v47
    v_cvt_pk_bf16_f32 v76, v48, v49
    v_mfma_f32_32x32x16_bf16 a[48:63], v[112:115], v[84:87], a[48:63]
    s_waitcnt vmcnt(18)
    buffer_load_dwordx4 v247, s[28:31], s59 offen offset:0 sc1 lds
    s_add_u32 m0, m0, 0x400
    v_exp_f32 v52, v52
    v_exp_f32 v53, v53
    v_exp_f32 v54, v54
    v_exp_f32 v55, v55
    v_cvt_pk_bf16_f32 v77, v50, v51
    v_cvt_pk_bf16_f32 v78, v52, v53
    v_cvt_pk_bf16_f32 v79, v54, v55
    v_mfma_f32_32x32x16_bf16 v[40:55], v[92:95], v[16:19], 0
    buffer_load_dwordx4 v248, s[28:31], s59 offen offset:0 sc1 lds
    v_exp_f32 v56, v56
    v_exp_f32 v57, v57
    v_exp_f32 v58, v58
    v_exp_f32 v59, v59
    v_cvt_pk_bf16_f32 v80, v56, v57
    v_mfma_f32_32x32x8_bf16 v[40:55], v[102:103], v[32:33], v[40:55]
    v_exp_f32 v60, v60
    v_exp_f32 v61, v61
    v_exp_f32 v62, v62
    v_exp_f32 v63, v63
    v_cvt_pk_bf16_f32 v81, v58, v59
    v_cvt_pk_bf16_f32 v82, v60, v61
    v_mfma_f32_32x32x16_bf16 a[32:47], v[116:119], v[72:75], a[32:47]
    v_exp_f32 v64, v64
    v_exp_f32 v65, v65
    v_exp_f32 v66, v66
    v_exp_f32 v67, v67
    v_cvt_pk_bf16_f32 v83, v62, v63
    v_cvt_pk_bf16_f32 v84, v64, v65
    v_mfma_f32_32x32x16_bf16 a[32:47], v[120:123], v[76:79], a[32:47]
    v_exp_f32 v68, v68
    v_exp_f32 v69, v69
    v_exp_f32 v70, v70
    v_exp_f32 v71, v71
    v_cvt_pk_bf16_f32 v85, v66, v67
    v_cvt_pk_bf16_f32 v86, v68, v69
    v_cvt_pk_bf16_f32 v87, v70, v71
    v_mfma_f32_32x32x16_bf16 v[56:71], v[92:95], v[20:23], 0
    v_exp_f32 v40, v40
    v_exp_f32 v41, v41
    v_exp_f32 v42, v42
    v_exp_f32 v43, v43
    v_cvt_pk_bf16_f32 v72, v40, v41
    v_mfma_f32_32x32x8_bf16 v[56:71], v[102:103], v[34:35], v[56:71]
    v_exp_f32 v44, v44
    v_exp_f32 v45, v45
    v_exp_f32 v46, v46
    v_exp_f32 v47, v47
    v_cvt_pk_bf16_f32 v73, v42, v43
    v_cvt_pk_bf16_f32 v74, v44, v45
    v_mfma_f32_32x32x16_bf16 a[48:63], v[116:119], v[80:83], a[48:63]
    ds_write_b128 v11, a[32:35] offset:0
    ds_write_b128 v11, a[36:39] offset:1024
    v_exp_f32 v48, v48
    v_exp_f32 v49, v49
    v_exp_f32 v50, v50
    v_exp_f32 v51, v51
    v_cvt_pk_bf16_f32 v75, v46, v47
    v_cvt_pk_bf16_f32 v76, v48, v49
    v_mfma_f32_32x32x16_bf16 a[48:63], v[120:123], v[84:87], a[48:63]
    ds_write_b128 v11, a[40:43] offset:2048
    v_exp_f32 v52, v52
    v_exp_f32 v53, v53
    v_exp_f32 v54, v54
    v_exp_f32 v55, v55
    v_cvt_pk_bf16_f32 v77, v50, v51
    v_cvt_pk_bf16_f32 v78, v52, v53
    v_cvt_pk_bf16_f32 v79, v54, v55
    s_nop 0
    v_exp_f32 v56, v56
    v_exp_f32 v57, v57
    v_exp_f32 v58, v58
    v_exp_f32 v59, v59
    v_cvt_pk_bf16_f32 v80, v56, v57
    s_nop 0
    v_exp_f32 v60, v60
    v_exp_f32 v61, v61
    v_exp_f32 v62, v62
    v_exp_f32 v63, v63
    v_cvt_pk_bf16_f32 v81, v58, v59
    v_cvt_pk_bf16_f32 v82, v60, v61
    v_mfma_f32_32x32x16_bf16 a[0:15], v[116:119], v[72:75], a[0:15]
    ds_write_b128 v11, a[48:51] offset:3072
    ds_write_b128 v11, a[52:55] offset:4096
    v_exp_f32 v64, v64
    v_exp_f32 v65, v65
    v_exp_f32 v66, v66
    v_exp_f32 v67, v67
    v_cvt_pk_bf16_f32 v83, v62, v63
    v_cvt_pk_bf16_f32 v84, v64, v65
    v_mfma_f32_32x32x16_bf16 a[0:15], v[120:123], v[76:79], a[0:15]
    ds_write_b128 v11, a[56:59] offset:5120
    v_exp_f32 v68, v68
    v_exp_f32 v69, v69
    v_exp_f32 v70, v70
    v_exp_f32 v71, v71
    v_cvt_pk_bf16_f32 v85, v66, v67
    v_cvt_pk_bf16_f32 v86, v68, v69
    v_cvt_pk_bf16_f32 v87, v70, v71
    v_mfma_f32_32x32x16_bf16 a[16:31], v[116:119], v[80:83], a[16:31]
    s_waitcnt lgkmcnt(0)
    s_barrier
    ds_read_b128 v[88:91], v12 offset:0
    ds_read_b128 v[92:95], v12 offset:1024
    ds_read_b128 v[96:99], v12 offset:2048
    ds_read_b128 v[100:103], v12 offset:3072
    ds_read_b128 v[104:107], v12 offset:4096
    ds_read_b128 v[204:207], v12 offset:5120
    v_mfma_f32_32x32x16_bf16 a[16:31], v[120:123], v[84:87], a[16:31]
    s_waitcnt vmcnt(3)
    v_cmp_ne_u32 vcc, 1, v213
    s_nop 1
    s_cbranch_vccz SYNC2_DONE
    s_mov_b32 s3, 1048576
SYNC2_SPIN:
    buffer_load_dword v213, v212, s[28:31], s39 offen sc1
    s_waitcnt vmcnt(0)
    v_cmp_ne_u32 vcc, 1, v213
    s_sub_u32 s3, s3, 1
    s_cbranch_scc1 SYNC2_DONE
    s_cbranch_vccz SYNC2_DONE
    s_sleep 1
    s_branch SYNC2_SPIN
SYNC2_DONE:
    buffer_load_dwordx4 v[112:115], v208, s[28:31], s16 offen offset:0 sc1
    buffer_load_dwordx4 v[116:119], v209, s[28:31], s16 offen offset:0 sc1
    buffer_load_dwordx4 v[120:123], v210, s[28:31], s16 offen offset:0 sc1
    buffer_load_dwordx4 v[124:127], v211, s[28:31], s16 offen offset:0 sc1
    buffer_load_dwordx4 v[128:131], v208, s[28:31], s16 offen offset:2048 sc1
    buffer_load_dwordx4 v[132:135], v209, s[28:31], s16 offen offset:2048 sc1
    buffer_load_dwordx4 v[136:139], v210, s[28:31], s16 offen offset:2048 sc1
    buffer_load_dwordx4 v[140:143], v211, s[28:31], s16 offen offset:2048 sc1
    v_accvgpr_read_b32 v40, a0
    v_accvgpr_read_b32 v41, a1
    v_accvgpr_read_b32 v42, a2
    v_accvgpr_read_b32 v43, a3
    v_accvgpr_read_b32 v44, a4
    v_accvgpr_read_b32 v45, a5
    v_accvgpr_read_b32 v46, a6
    v_accvgpr_read_b32 v47, a7
    v_accvgpr_read_b32 v48, a8
    v_accvgpr_read_b32 v49, a9
    v_accvgpr_read_b32 v50, a10
    v_accvgpr_read_b32 v51, a11
    v_accvgpr_read_b32 v56, a16
    v_accvgpr_read_b32 v57, a17
    v_accvgpr_read_b32 v58, a18
    v_accvgpr_read_b32 v59, a19
    v_accvgpr_read_b32 v60, a20
    v_accvgpr_read_b32 v61, a21
    v_accvgpr_read_b32 v62, a22
    v_accvgpr_read_b32 v63, a23
    v_accvgpr_read_b32 v64, a24
    v_accvgpr_read_b32 v65, a25
    v_accvgpr_read_b32 v66, a26
    v_accvgpr_read_b32 v67, a27
    s_mov_b32 s5, 0
    s_waitcnt lgkmcnt(0)
    v_pk_add_f32 v[40:41], v[40:41], v[88:89]
    v_pk_add_f32 v[42:43], v[42:43], v[90:91]
    v_pk_add_f32 v[44:45], v[44:45], v[92:93]
    v_pk_add_f32 v[46:47], v[46:47], v[94:95]
    v_pk_add_f32 v[48:49], v[48:49], v[96:97]
    v_pk_add_f32 v[50:51], v[50:51], v[98:99]
    v_pk_add_f32 v[56:57], v[56:57], v[100:101]
    v_pk_add_f32 v[58:59], v[58:59], v[102:103]
    v_pk_add_f32 v[60:61], v[60:61], v[104:105]
    v_pk_add_f32 v[62:63], v[62:63], v[106:107]
    v_pk_add_f32 v[64:65], v[64:65], v[204:205]
    v_pk_add_f32 v[66:67], v[66:67], v[206:207]
    buffer_load_dwordx4 v[96:99], v208, s[28:31], s22 offen offset:0 sc1
    buffer_load_dwordx4 v[100:103], v209, s[28:31], s22 offen offset:0 sc1
    buffer_load_dwordx4 v[104:107], v210, s[28:31], s22 offen offset:0 sc1
    buffer_load_dwordx4 v[108:111], v211, s[28:31], s22 offen offset:0 sc1
P2_FIN:
    v_mov_b32 v32, v48
    v_mov_b32 v33, v48
    v_mov_b32 v34, v64
    v_mov_b32 v35, v64
    s_nop 0
    s_nop 0
    v_permlane32_swap_b32 v32, v33
    v_permlane32_swap_b32 v34, v35
    s_nop 0
    s_nop 0
    v_rcp_f32 v32, v33
    v_rcp_f32 v34, v35
    v_mov_b32 v38, 0
    v_mul_f32 v32, v32, v14
    v_mul_f32 v34, v34, v15
    v_pk_mul_f32 v[40:41], v[40:41], v[32:33] op_sel_hi:[1,0]
    v_pk_mul_f32 v[42:43], v[42:43], v[32:33] op_sel_hi:[1,0]
    v_pk_mul_f32 v[44:45], v[44:45], v[32:33] op_sel_hi:[1,0]
    v_pk_mul_f32 v[46:47], v[46:47], v[32:33] op_sel_hi:[1,0]
    v_pk_mul_f32 v[48:49], v[48:49], v[32:33] op_sel_hi:[1,0]
    v_pk_mul_f32 v[50:51], v[50:51], v[32:33] op_sel_hi:[1,0]
    v_pk_mul_f32 v[56:57], v[56:57], v[34:35] op_sel_hi:[1,0]
    v_pk_mul_f32 v[58:59], v[58:59], v[34:35] op_sel_hi:[1,0]
    v_pk_mul_f32 v[60:61], v[60:61], v[34:35] op_sel_hi:[1,0]
    v_pk_mul_f32 v[62:63], v[62:63], v[34:35] op_sel_hi:[1,0]
    v_pk_mul_f32 v[64:65], v[64:65], v[34:35] op_sel_hi:[1,0]
    v_pk_mul_f32 v[66:67], v[66:67], v[34:35] op_sel_hi:[1,0]
    v_mov_b32 v39, 0
    v_pk_fma_f32 v[38:39], v[40:41], 0, v[38:39] op_sel_hi:[1,0,1]
    v_pk_fma_f32 v[38:39], v[42:43], 0, v[38:39] op_sel_hi:[1,0,1]
    v_pk_fma_f32 v[38:39], v[44:45], 0, v[38:39] op_sel_hi:[1,0,1]
    v_pk_fma_f32 v[38:39], v[46:47], 0, v[38:39] op_sel_hi:[1,0,1]
    v_pk_fma_f32 v[38:39], v[48:49], 0, v[38:39] op_sel_hi:[1,0,1]
    v_pk_fma_f32 v[38:39], v[50:51], 0, v[38:39] op_sel_hi:[1,0,1]
    v_pk_fma_f32 v[38:39], v[56:57], 0, v[38:39] op_sel_hi:[1,0,1]
    v_pk_fma_f32 v[38:39], v[58:59], 0, v[38:39] op_sel_hi:[1,0,1]
    v_pk_fma_f32 v[38:39], v[60:61], 0, v[38:39] op_sel_hi:[1,0,1]
    v_pk_fma_f32 v[38:39], v[62:63], 0, v[38:39] op_sel_hi:[1,0,1]
    v_pk_fma_f32 v[38:39], v[64:65], 0, v[38:39] op_sel_hi:[1,0,1]
    v_pk_fma_f32 v[38:39], v[66:67], 0, v[38:39] op_sel_hi:[1,0,1]
    v_add_f32 v38, v38, v39
    v_min_f32 v36, v33, v35
    v_max_f32 v37, v33, v35
    s_mov_b32 s60, 0x30800000
    s_mov_b32 s61, 0x5d800000
    v_cmp_le_f32 s[12:13], s60, v36
    v_cmp_ge_f32 s[14:15], s61, v37
    v_cmp_o_f32 s[60:61], v33, v35
    v_cmp_eq_f32 vcc, 0, v38
    s_and_b64 s[12:13], s[12:13], s[14:15]
    s_and_b64 s[12:13], s[12:13], s[60:61]
    s_and_b64 s[12:13], s[12:13], vcc
    s_cmp_eq_u64 s[12:13], -1
    s_cselect_b32 s12, 1, 0
    s_or_b32 s12, s12, s5
    s_cmp_eq_u32 s12, 0
    s_cbranch_scc1 P2_SLOW
    v_cvt_pk_bf16_f32 v72, v40, v41
    v_cvt_pk_bf16_f32 v73, v42, v43
    v_cvt_pk_bf16_f32 v74, v44, v45
    v_cvt_pk_bf16_f32 v75, v46, v47
    v_cvt_pk_bf16_f32 v76, v48, v49
    v_cvt_pk_bf16_f32 v77, v50, v51
    v_cvt_pk_bf16_f32 v80, v56, v57
    v_cvt_pk_bf16_f32 v81, v58, v59
    v_cvt_pk_bf16_f32 v82, v60, v61
    v_cvt_pk_bf16_f32 v83, v62, v63
    v_cvt_pk_bf16_f32 v84, v64, v65
    v_cvt_pk_bf16_f32 v85, v66, v67
    s_mul_i32 s12, s33, 40960
    s_mul_i32 s13, s37, 1280
    s_add_u32 s12, s12, s13
    s_add_u32 s12, s12, 0xf00000
    s_add_u32 s13, s12, 40960
    v_mul_u32_u24 v88, 0x7f0000, v2
    v_lshl_add_u32 v88, v88, 8, v7
    buffer_store_dwordx4 v[72:75], v3, s[28:31], s12 offen sc1
    buffer_store_dwordx2 v[76:77], v88, s[28:31], s12 offen offset:1024 sc1
    buffer_store_dwordx4 v[80:83], v3, s[28:31], s13 offen sc1
    buffer_store_dwordx2 v[84:85], v88, s[28:31], s13 offen offset:1024 sc1
    s_lshl_b32 s12, s33, 4
    s_add_u32 s12, s12, s37
    s_lshl_b32 s12, s12, 7
    s_add_u32 s62, s12, 0x1498000
P3_SETUP:
    s_load_dwordx2 s[12:13], s[0:1], 64
    v_mov_b32 v214, 1
    s_mov_b32 s37, s63
    v_lshrrev_b32 v2, 4, v1
    v_and_b32 v3, 15, v1
    v_lshlrev_b32 v4, 4, v3
    s_mov_b32 s15, 0x1498000
    s_mul_i32 s42, s36, 30720
    s_add_u32 s42, s42, 24576
    v_lshlrev_b32 v223, 4, v1
    v_add_u32 v223, s42, v223
    s_waitcnt vmcnt(15)
    v_mfma_f32_16x16x32_bf16 v[16:19], a[64:67], v[112:115], 0
    s_and_b32 s38, s6, 1
    v_mfma_f32_16x16x32_bf16 v[20:23], a[68:71], v[112:115], 0
    s_lshl_b32 s38, s38, 2
    v_mfma_f32_16x16x32_bf16 v[24:27], a[72:75], v[112:115], 0
    s_lshr_b32 s42, s7, 3
    v_mfma_f32_16x16x32_bf16 v[28:31], a[76:79], v[112:115], 0
    s_add_u32 s38, s38, s42
    v_mfma_f32_16x16x32_bf16 v[32:35], a[80:83], v[112:115], 0
    buffer_load_dwordx4 v[112:115], v208, s[28:31], s22 offen offset:2048 sc1
    s_waitcnt vmcnt(15)
    v_mfma_f32_16x16x32_bf16 v[36:39], a[64:67], v[116:119], 0
    s_movk_i32 s63, 5120
    v_mfma_f32_16x16x32_bf16 v[40:43], a[68:71], v[116:119], 0
    v_lshrrev_b32 v6, 1, v2
    v_mfma_f32_16x16x32_bf16 v[44:47], a[72:75], v[116:119], 0
    v_mul_u32_u24 v6, 1280, v6
    v_mfma_f32_16x16x32_bf16 v[48:51], a[76:79], v[116:119], 0
    v_and_b32 v7, 1, v2
    v_mfma_f32_16x16x32_bf16 v[52:55], a[80:83], v[116:119], 0
    buffer_load_dwordx4 v[116:119], v209, s[28:31], s22 offen offset:2048 sc1
    s_waitcnt vmcnt(15)
    v_mfma_f32_16x16x32_bf16 v[56:59], a[64:67], v[120:123], 0
    v_lshl_add_u32 v6, v7, 9, v6
    v_mfma_f32_16x16x32_bf16 v[60:63], a[68:71], v[120:123], 0
    v_add_u32 v6, v6, v4
    v_mfma_f32_16x16x32_bf16 v[64:67], a[72:75], v[120:123], 0
    v_mul_u32_u24 v7, 2560, v2
    v_mfma_f32_16x16x32_bf16 v[68:71], a[76:79], v[120:123], 0
    v_lshl_add_u32 v7, v3, 3, v7
    v_mfma_f32_16x16x32_bf16 v[72:75], a[80:83], v[120:123], 0
    buffer_load_dwordx4 v[120:123], v210, s[28:31], s22 offen offset:2048 sc1
    s_waitcnt vmcnt(15)
    v_mfma_f32_16x16x32_bf16 v[76:79], a[64:67], v[124:127], 0
    s_mul_i32 s46, s37, 81920
    v_mfma_f32_16x16x32_bf16 v[80:83], a[68:71], v[124:127], 0
    s_mul_i32 s47, s36, 10240
    v_mfma_f32_16x16x32_bf16 v[84:87], a[72:75], v[124:127], 0
    s_add_u32 s46, s46, s47
    v_mfma_f32_16x16x32_bf16 v[88:91], a[76:79], v[124:127], 0
    s_add_u32 s46, s46, 0xf00000
    v_mfma_f32_16x16x32_bf16 v[92:95], a[80:83], v[124:127], 0
    buffer_load_dwordx4 v[124:127], v211, s[28:31], s22 offen offset:2048 sc1
    s_waitcnt vmcnt(15)
    v_mfma_f32_16x16x32_bf16 v[16:19], a[84:87], v[128:131], v[16:19]
    v_add_u32 v224, s46, v6
    v_mfma_f32_16x16x32_bf16 v[20:23], a[88:91], v[128:131], v[20:23]
    v_add_u32 v225, 256, v224
    v_mfma_f32_16x16x32_bf16 v[24:27], a[92:95], v[128:131], v[24:27]
    v_add_u32 v226, 40960, v224
    v_mfma_f32_16x16x32_bf16 v[28:31], a[96:99], v[128:131], v[28:31]
    v_add_u32 v227, 41216, v224
    v_mfma_f32_16x16x32_bf16 v[32:35], a[100:103], v[128:131], v[32:35]
    buffer_load_dwordx4 v[128:131], v208, s[28:31], s27 offen offset:0 sc1
    s_waitcnt vmcnt(15)
    v_mfma_f32_16x16x32_bf16 v[36:39], a[84:87], v[132:135], v[36:39]
    v_add_u32 v228, s46, v7
    v_mfma_f32_16x16x32_bf16 v[40:43], a[88:91], v[132:135], v[40:43]
    v_add_u32 v229, 128, v228
    v_mfma_f32_16x16x32_bf16 v[44:47], a[92:95], v[132:135], v[44:47]
    v_add_u32 v230, 40960, v228
    v_mfma_f32_16x16x32_bf16 v[48:51], a[96:99], v[132:135], v[48:51]
    v_add_u32 v231, 41088, v228
    v_mfma_f32_16x16x32_bf16 v[52:55], a[100:103], v[132:135], v[52:55]
    buffer_load_dwordx4 v[132:135], v209, s[28:31], s27 offen offset:0 sc1
    s_waitcnt vmcnt(15)
    v_mfma_f32_16x16x32_bf16 v[56:59], a[84:87], v[136:139], v[56:59]
    v_mul_u32_u24 v222, 336, v3
    v_mfma_f32_16x16x32_bf16 v[60:63], a[88:91], v[136:139], v[60:63]
    v_lshl_add_u32 v222, v2, 4, v222
    v_mfma_f32_16x16x32_bf16 v[64:67], a[92:95], v[136:139], v[64:67]
    s_mul_i32 s42, s36, 30720
    v_mfma_f32_16x16x32_bf16 v[68:71], a[96:99], v[136:139], v[68:71]
    s_add_u32 s42, s42, 24576
    v_mfma_f32_16x16x32_bf16 v[72:75], a[100:103], v[136:139], v[72:75]
    buffer_load_dwordx4 v[136:139], v210, s[28:31], s27 offen offset:0 sc1
    s_waitcnt vmcnt(15)
    v_mfma_f32_16x16x32_bf16 v[76:79], a[84:87], v[140:143], v[76:79]
    v_add_u32 v222, s42, v222
    v_mfma_f32_16x16x32_bf16 v[80:83], a[88:91], v[140:143], v[80:83]
    s_mul_i32 s42, s37, 81920
    v_mfma_f32_16x16x32_bf16 v[84:87], a[92:95], v[140:143], v[84:87]
    s_mul_i32 s43, s38, 160
    v_mfma_f32_16x16x32_bf16 v[88:91], a[96:99], v[140:143], v[88:91]
    s_add_u32 s42, s42, s43
    v_mfma_f32_16x16x32_bf16 v[92:95], a[100:103], v[140:143], v[92:95]
    buffer_load_dwordx4 v[140:143], v211, s[28:31], s27 offen offset:0 sc1
    s_waitcnt vmcnt(8)
    buffer_store_dword v214, v249, s[28:31], s62 offen sc1
    s_waitcnt vmcnt(16)
    v_mfma_f32_16x16x32_bf16 v[16:19], a[104:107], v[96:99], v[16:19]
    s_waitcnt lgkmcnt(0)
    v_mfma_f32_16x16x32_bf16 v[20:23], a[108:111], v[96:99], v[20:23]
    s_mov_b32 s32, s12
    v_mfma_f32_16x16x32_bf16 v[24:27], a[112:115], v[96:99], v[24:27]
    s_mov_b32 s33, s13
    v_mfma_f32_16x16x32_bf16 v[28:31], a[116:119], v[96:99], v[28:31]
    s_mov_b32 s34, 2621440
    v_mfma_f32_16x16x32_bf16 v[32:35], a[120:123], v[96:99], v[32:35]
    buffer_load_dwordx4 v[96:99], v208, s[28:31], s27 offen offset:2048 sc1
    s_waitcnt vmcnt(16)
    v_mfma_f32_16x16x32_bf16 v[36:39], a[104:107], v[100:103], v[36:39]
    s_mov_b32 s35, 0x00020000
    v_mfma_f32_16x16x32_bf16 v[40:43], a[108:111], v[100:103], v[40:43]
    v_add_u32 v12, 0, v0
    v_mfma_f32_16x16x32_bf16 v[44:47], a[112:115], v[100:103], v[44:47]
    v_mul_u32_u24 v13, 3277, v12
    v_mfma_f32_16x16x32_bf16 v[48:51], a[116:119], v[100:103], v[48:51]
    v_lshrrev_b32 v13, 16, v13
    v_mfma_f32_16x16x32_bf16 v[52:55], a[120:123], v[100:103], v[52:55]
    buffer_load_dwordx4 v[100:103], v209, s[28:31], s27 offen offset:2048 sc1
    s_waitcnt vmcnt(16)
    v_mfma_f32_16x16x32_bf16 v[56:59], a[104:107], v[104:107], v[56:59]
    v_mul_u32_u24 v14, 20, v13
    v_mfma_f32_16x16x32_bf16 v[60:63], a[108:111], v[104:107], v[60:63]
    v_sub_u32 v14, v12, v14
    v_mfma_f32_16x16x32_bf16 v[64:67], a[112:115], v[104:107], v[64:67]
    v_mul_u32_u24 v15, 336, v13
    v_mfma_f32_16x16x32_bf16 v[68:71], a[116:119], v[104:107], v[68:71]
    v_lshl_add_u32 v237, v14, 4, v15
    v_mfma_f32_16x16x32_bf16 v[72:75], a[120:123], v[104:107], v[72:75]
    buffer_load_dwordx4 v[104:107], v210, s[28:31], s27 offen offset:2048 sc1
    s_waitcnt vmcnt(16)
    v_mfma_f32_16x16x32_bf16 v[76:79], a[104:107], v[108:111], v[76:79]
    v_add_u32 v237, 24576, v237
    v_mfma_f32_16x16x32_bf16 v[80:83], a[108:111], v[108:111], v[80:83]
    v_mul_u32_u24 v15, 1280, v13
    v_mfma_f32_16x16x32_bf16 v[84:87], a[112:115], v[108:111], v[84:87]
    v_lshl_add_u32 v232, v14, 3, v15
    v_mfma_f32_16x16x32_bf16 v[88:91], a[116:119], v[108:111], v[88:91]
    v_add_u32 v215, 61440, v237
    v_mfma_f32_16x16x32_bf16 v[92:95], a[120:123], v[108:111], v[92:95]
    buffer_load_dwordx4 v[108:111], v211, s[28:31], s27 offen offset:2048 sc1
    s_waitcnt vmcnt(12)
    v_mfma_f32_16x16x32_bf16 v[16:19], a[124:127], v[112:115], v[16:19]
    v_add_u32 v12, 256, v0
    v_mfma_f32_16x16x32_bf16 v[20:23], a[128:131], v[112:115], v[20:23]
    v_mul_u32_u24 v13, 3277, v12
    v_mfma_f32_16x16x32_bf16 v[24:27], a[132:135], v[112:115], v[24:27]
    v_lshrrev_b32 v13, 16, v13
    v_mfma_f32_16x16x32_bf16 v[28:31], a[136:139], v[112:115], v[28:31]
    v_mul_u32_u24 v14, 20, v13
    v_mfma_f32_16x16x32_bf16 v[32:35], a[140:143], v[112:115], v[32:35]
    buffer_load_dwordx4 v[112:115], v208, s[28:31], s17 offen offset:0 sc1
    s_waitcnt vmcnt(12)
    v_mfma_f32_16x16x32_bf16 v[36:39], a[124:127], v[116:119], v[36:39]
    v_sub_u32 v14, v12, v14
    v_mfma_f32_16x16x32_bf16 v[40:43], a[128:131], v[116:119], v[40:43]
    v_mul_u32_u24 v15, 336, v13
    v_mfma_f32_16x16x32_bf16 v[44:47], a[132:135], v[116:119], v[44:47]
    v_lshl_add_u32 v238, v14, 4, v15
    v_mfma_f32_16x16x32_bf16 v[48:51], a[136:139], v[116:119], v[48:51]
    v_add_u32 v238, 24576, v238
    v_mfma_f32_16x16x32_bf16 v[52:55], a[140:143], v[116:119], v[52:55]
    buffer_load_dwordx4 v[116:119], v209, s[28:31], s17 offen offset:0 sc1
    s_waitcnt vmcnt(12)
    v_mfma_f32_16x16x32_bf16 v[56:59], a[124:127], v[120:123], v[56:59]
    v_mul_u32_u24 v15, 1280, v13
    v_mfma_f32_16x16x32_bf16 v[60:63], a[128:131], v[120:123], v[60:63]
    v_lshl_add_u32 v233, v14, 3, v15
    v_mfma_f32_16x16x32_bf16 v[64:67], a[132:135], v[120:123], v[64:67]
    v_add_u32 v216, 61440, v238
    v_mfma_f32_16x16x32_bf16 v[68:71], a[136:139], v[120:123], v[68:71]
    v_add_u32 v12, 512, v0
    v_mfma_f32_16x16x32_bf16 v[72:75], a[140:143], v[120:123], v[72:75]
    buffer_load_dwordx4 v[120:123], v210, s[28:31], s17 offen offset:0 sc1
    s_waitcnt vmcnt(12)
    v_mfma_f32_16x16x32_bf16 v[76:79], a[124:127], v[124:127], v[76:79]
    v_mul_u32_u24 v13, 3277, v12
    v_mfma_f32_16x16x32_bf16 v[80:83], a[128:131], v[124:127], v[80:83]
    v_lshrrev_b32 v13, 16, v13
    v_mfma_f32_16x16x32_bf16 v[84:87], a[132:135], v[124:127], v[84:87]
    v_mul_u32_u24 v14, 20, v13
    v_mfma_f32_16x16x32_bf16 v[88:91], a[136:139], v[124:127], v[88:91]
    v_sub_u32 v14, v12, v14
    v_mfma_f32_16x16x32_bf16 v[92:95], a[140:143], v[124:127], v[92:95]
    buffer_load_dwordx4 v[124:127], v211, s[28:31], s17 offen offset:0 sc1
    s_waitcnt vmcnt(12)
    v_mfma_f32_16x16x32_bf16 v[16:19], a[144:147], v[128:131], v[16:19]
    v_mul_u32_u24 v15, 336, v13
    v_mfma_f32_16x16x32_bf16 v[20:23], a[148:151], v[128:131], v[20:23]
    v_lshl_add_u32 v239, v14, 4, v15
    v_mfma_f32_16x16x32_bf16 v[24:27], a[152:155], v[128:131], v[24:27]
    v_add_u32 v239, 24576, v239
    v_mfma_f32_16x16x32_bf16 v[28:31], a[156:159], v[128:131], v[28:31]
    v_mul_u32_u24 v15, 1280, v13
    v_mfma_f32_16x16x32_bf16 v[32:35], a[160:163], v[128:131], v[32:35]
    buffer_load_dwordx4 v[128:131], v208, s[28:31], s17 offen offset:2048 sc1
    s_waitcnt vmcnt(12)
    v_mfma_f32_16x16x32_bf16 v[36:39], a[144:147], v[132:135], v[36:39]
    v_lshl_add_u32 v234, v14, 3, v15
    v_mfma_f32_16x16x32_bf16 v[40:43], a[148:151], v[132:135], v[40:43]
    v_add_u32 v217, 61440, v239
    v_mfma_f32_16x16x32_bf16 v[44:47], a[152:155], v[132:135], v[44:47]
    v_add_u32 v12, 768, v0
    v_mfma_f32_16x16x32_bf16 v[48:51], a[156:159], v[132:135], v[48:51]
    v_mul_u32_u24 v13, 3277, v12
    v_mfma_f32_16x16x32_bf16 v[52:55], a[160:163], v[132:135], v[52:55]
    buffer_load_dwordx4 v[132:135], v209, s[28:31], s17 offen offset:2048 sc1
    s_waitcnt vmcnt(12)
    v_mfma_f32_16x16x32_bf16 v[56:59], a[144:147], v[136:139], v[56:59]
    v_lshrrev_b32 v13, 16, v13
    v_mfma_f32_16x16x32_bf16 v[60:63], a[148:151], v[136:139], v[60:63]
    v_mul_u32_u24 v14, 20, v13
    v_mfma_f32_16x16x32_bf16 v[64:67], a[152:155], v[136:139], v[64:67]
    v_sub_u32 v14, v12, v14
    v_mfma_f32_16x16x32_bf16 v[68:71], a[156:159], v[136:139], v[68:71]
    v_mul_u32_u24 v15, 336, v13
    v_mfma_f32_16x16x32_bf16 v[72:75], a[160:163], v[136:139], v[72:75]
    buffer_load_dwordx4 v[136:139], v210, s[28:31], s17 offen offset:2048 sc1
    s_waitcnt vmcnt(12)
    v_mfma_f32_16x16x32_bf16 v[76:79], a[144:147], v[140:143], v[76:79]
    v_lshl_add_u32 v240, v14, 4, v15
    v_mfma_f32_16x16x32_bf16 v[80:83], a[148:151], v[140:143], v[80:83]
    v_add_u32 v240, 24576, v240
    v_mfma_f32_16x16x32_bf16 v[84:87], a[152:155], v[140:143], v[84:87]
    v_mul_u32_u24 v15, 1280, v13
    v_mfma_f32_16x16x32_bf16 v[88:91], a[156:159], v[140:143], v[88:91]
    v_lshl_add_u32 v235, v14, 3, v15
    v_mfma_f32_16x16x32_bf16 v[92:95], a[160:163], v[140:143], v[92:95]
    buffer_load_dwordx4 v[140:143], v211, s[28:31], s17 offen offset:2048 sc1
    s_waitcnt vmcnt(11)
    v_mfma_f32_16x16x32_bf16 v[16:19], a[164:167], v[96:99], v[16:19]
    v_add_u32 v218, 61440, v240
    v_mfma_f32_16x16x32_bf16 v[20:23], a[168:171], v[96:99], v[20:23]
    v_add_u32 v12, 1024, v0
    v_mfma_f32_16x16x32_bf16 v[24:27], a[172:175], v[96:99], v[24:27]
    v_mul_u32_u24 v13, 3277, v12
    v_mfma_f32_16x16x32_bf16 v[28:31], a[176:179], v[96:99], v[28:31]
    v_lshrrev_b32 v13, 16, v13
    v_mfma_f32_16x16x32_bf16 v[32:35], a[180:183], v[96:99], v[32:35]
    buffer_load_dwordx4 v[96:99], v208, s[28:31], s9 offen offset:0 sc1
    s_waitcnt vmcnt(11)
    v_mfma_f32_16x16x32_bf16 v[36:39], a[164:167], v[100:103], v[36:39]
    v_mul_u32_u24 v14, 20, v13
    v_mfma_f32_16x16x32_bf16 v[40:43], a[168:171], v[100:103], v[40:43]
    v_sub_u32 v14, v12, v14
    v_mfma_f32_16x16x32_bf16 v[44:47], a[172:175], v[100:103], v[44:47]
    v_mul_u32_u24 v15, 336, v13
    v_mfma_f32_16x16x32_bf16 v[48:51], a[176:179], v[100:103], v[48:51]
    v_lshl_add_u32 v241, v14, 4, v15
    v_mfma_f32_16x16x32_bf16 v[52:55], a[180:183], v[100:103], v[52:55]
    buffer_load_dwordx4 v[100:103], v209, s[28:31], s9 offen offset:0 sc1
    s_waitcnt vmcnt(11)
    v_mfma_f32_16x16x32_bf16 v[56:59], a[164:167], v[104:107], v[56:59]
    v_add_u32 v241, 24576, v241
    v_mfma_f32_16x16x32_bf16 v[60:63], a[168:171], v[104:107], v[60:63]
    v_mul_u32_u24 v15, 1280, v13
    v_mfma_f32_16x16x32_bf16 v[64:67], a[172:175], v[104:107], v[64:67]
    v_lshl_add_u32 v236, v14, 3, v15
    v_mfma_f32_16x16x32_bf16 v[68:71], a[176:179], v[104:107], v[68:71]
    v_add_u32 v219, 61440, v241
    v_mfma_f32_16x16x32_bf16 v[72:75], a[180:183], v[104:107], v[72:75]
    buffer_load_dwordx4 v[104:107], v210, s[28:31], s9 offen offset:0 sc1
    s_waitcnt vmcnt(11)
    v_mfma_f32_16x16x32_bf16 v[76:79], a[164:167], v[108:111], v[76:79]
    v_mfma_f32_16x16x32_bf16 v[80:83], a[168:171], v[108:111], v[80:83]
    v_mfma_f32_16x16x32_bf16 v[84:87], a[172:175], v[108:111], v[84:87]
    v_mfma_f32_16x16x32_bf16 v[88:91], a[176:179], v[108:111], v[88:91]
    v_mfma_f32_16x16x32_bf16 v[92:95], a[180:183], v[108:111], v[92:95]
    buffer_load_dwordx4 v[108:111], v211, s[28:31], s9 offen offset:0 sc1
    s_waitcnt vmcnt(11)
    v_mfma_f32_16x16x32_bf16 v[16:19], a[184:187], v[112:115], v[16:19]
    v_mfma_f32_16x16x32_bf16 v[20:23], a[188:191], v[112:115], v[20:23]
    v_mfma_f32_16x16x32_bf16 v[24:27], a[192:195], v[112:115], v[24:27]
    v_mfma_f32_16x16x32_bf16 v[28:31], a[196:199], v[112:115], v[28:31]
    v_mfma_f32_16x16x32_bf16 v[32:35], a[200:203], v[112:115], v[32:35]
    buffer_load_dwordx4 v[112:115], v208, s[28:31], s9 offen offset:2048 sc1
    s_waitcnt vmcnt(11)
    v_mfma_f32_16x16x32_bf16 v[36:39], a[184:187], v[116:119], v[36:39]
    v_mfma_f32_16x16x32_bf16 v[40:43], a[188:191], v[116:119], v[40:43]
    v_mfma_f32_16x16x32_bf16 v[44:47], a[192:195], v[116:119], v[44:47]
    v_mfma_f32_16x16x32_bf16 v[48:51], a[196:199], v[116:119], v[48:51]
    v_mfma_f32_16x16x32_bf16 v[52:55], a[200:203], v[116:119], v[52:55]
    buffer_load_dwordx4 v[116:119], v209, s[28:31], s9 offen offset:2048 sc1
    s_waitcnt vmcnt(11)
    v_mfma_f32_16x16x32_bf16 v[56:59], a[184:187], v[120:123], v[56:59]
    v_mfma_f32_16x16x32_bf16 v[60:63], a[188:191], v[120:123], v[60:63]
    v_mfma_f32_16x16x32_bf16 v[64:67], a[192:195], v[120:123], v[64:67]
    v_mfma_f32_16x16x32_bf16 v[68:71], a[196:199], v[120:123], v[68:71]
    v_mfma_f32_16x16x32_bf16 v[72:75], a[200:203], v[120:123], v[72:75]
    buffer_load_dwordx4 v[120:123], v210, s[28:31], s9 offen offset:2048 sc1
    s_waitcnt vmcnt(11)
    v_mfma_f32_16x16x32_bf16 v[76:79], a[184:187], v[124:127], v[76:79]
    v_mfma_f32_16x16x32_bf16 v[80:83], a[188:191], v[124:127], v[80:83]
    v_mfma_f32_16x16x32_bf16 v[84:87], a[192:195], v[124:127], v[84:87]
    v_mfma_f32_16x16x32_bf16 v[88:91], a[196:199], v[124:127], v[88:91]
    v_mfma_f32_16x16x32_bf16 v[92:95], a[200:203], v[124:127], v[92:95]
    buffer_load_dwordx4 v[124:127], v211, s[28:31], s9 offen offset:2048 sc1
    buffer_load_dword v213, v212, s[28:31], s15 offen sc1
    s_waitcnt vmcnt(12)
    v_mfma_f32_16x16x32_bf16 v[16:19], a[204:207], v[128:131], v[16:19]
    v_mfma_f32_16x16x32_bf16 v[20:23], a[208:211], v[128:131], v[20:23]
    v_mfma_f32_16x16x32_bf16 v[24:27], a[212:215], v[128:131], v[24:27]
    v_mfma_f32_16x16x32_bf16 v[28:31], a[216:219], v[128:131], v[28:31]
    v_mfma_f32_16x16x32_bf16 v[32:35], a[220:223], v[128:131], v[32:35]
    buffer_load_dwordx4 v[128:131], v208, s[28:31], s56 offen offset:0 sc1
    s_waitcnt vmcnt(12)
    v_mfma_f32_16x16x32_bf16 v[36:39], a[204:207], v[132:135], v[36:39]
    v_mfma_f32_16x16x32_bf16 v[40:43], a[208:211], v[132:135], v[40:43]
    v_mfma_f32_16x16x32_bf16 v[44:47], a[212:215], v[132:135], v[44:47]
    v_mfma_f32_16x16x32_bf16 v[48:51], a[216:219], v[132:135], v[48:51]
    v_mfma_f32_16x16x32_bf16 v[52:55], a[220:223], v[132:135], v[52:55]
    buffer_load_dwordx4 v[132:135], v209, s[28:31], s56 offen offset:0 sc1
    s_waitcnt vmcnt(12)
    v_mfma_f32_16x16x32_bf16 v[56:59], a[204:207], v[136:139], v[56:59]
    v_mfma_f32_16x16x32_bf16 v[60:63], a[208:211], v[136:139], v[60:63]
    v_mfma_f32_16x16x32_bf16 v[64:67], a[212:215], v[136:139], v[64:67]
    v_mfma_f32_16x16x32_bf16 v[68:71], a[216:219], v[136:139], v[68:71]
    v_mfma_f32_16x16x32_bf16 v[72:75], a[220:223], v[136:139], v[72:75]
    buffer_load_dwordx4 v[136:139], v210, s[28:31], s56 offen offset:0 sc1
    s_waitcnt vmcnt(12)
    v_mfma_f32_16x16x32_bf16 v[76:79], a[204:207], v[140:143], v[76:79]
    v_mfma_f32_16x16x32_bf16 v[80:83], a[208:211], v[140:143], v[80:83]
    v_mfma_f32_16x16x32_bf16 v[84:87], a[212:215], v[140:143], v[84:87]
    v_mfma_f32_16x16x32_bf16 v[88:91], a[216:219], v[140:143], v[88:91]
    v_mfma_f32_16x16x32_bf16 v[92:95], a[220:223], v[140:143], v[92:95]
    buffer_load_dwordx4 v[140:143], v211, s[28:31], s56 offen offset:0 sc1
    s_waitcnt vmcnt(12)
    v_mfma_f32_16x16x32_bf16 v[16:19], a[224:227], v[96:99], v[16:19]
    v_mfma_f32_16x16x32_bf16 v[20:23], a[228:231], v[96:99], v[20:23]
    ds_read_b128 a[32:35], v223 offset:0
    v_mfma_f32_16x16x32_bf16 v[24:27], a[232:235], v[96:99], v[24:27]
    v_mfma_f32_16x16x32_bf16 v[28:31], a[236:239], v[96:99], v[28:31]
    ds_read_b128 a[36:39], v223 offset:1024
    v_mfma_f32_16x16x32_bf16 v[32:35], a[240:243], v[96:99], v[32:35]
    buffer_load_dwordx4 v[96:99], v208, s[28:31], s56 offen offset:2048 sc1
    s_waitcnt vmcnt(12)
    v_mfma_f32_16x16x32_bf16 v[36:39], a[224:227], v[100:103], v[36:39]
    v_mfma_f32_16x16x32_bf16 v[40:43], a[228:231], v[100:103], v[40:43]
    v_mfma_f32_16x16x32_bf16 v[44:47], a[232:235], v[100:103], v[44:47]
    v_mfma_f32_16x16x32_bf16 v[48:51], a[236:239], v[100:103], v[48:51]
    ds_read_b128 a[40:43], v223 offset:2048
    v_mfma_f32_16x16x32_bf16 v[52:55], a[240:243], v[100:103], v[52:55]
    buffer_load_dwordx4 v[100:103], v209, s[28:31], s56 offen offset:2048 sc1
    s_waitcnt vmcnt(12)
    v_mfma_f32_16x16x32_bf16 v[56:59], a[224:227], v[104:107], v[56:59]
    v_mfma_f32_16x16x32_bf16 v[60:63], a[228:231], v[104:107], v[60:63]
    v_mfma_f32_16x16x32_bf16 v[64:67], a[232:235], v[104:107], v[64:67]
    v_mfma_f32_16x16x32_bf16 v[68:71], a[236:239], v[104:107], v[68:71]
    ds_read_b128 a[44:47], v223 offset:3072
    v_mfma_f32_16x16x32_bf16 v[72:75], a[240:243], v[104:107], v[72:75]
    buffer_load_dwordx4 v[104:107], v210, s[28:31], s56 offen offset:2048 sc1
    s_waitcnt vmcnt(12)
    v_mfma_f32_16x16x32_bf16 v[76:79], a[224:227], v[108:111], v[76:79]
    v_mfma_f32_16x16x32_bf16 v[80:83], a[228:231], v[108:111], v[80:83]
    v_mfma_f32_16x16x32_bf16 v[84:87], a[232:235], v[108:111], v[84:87]
    v_mfma_f32_16x16x32_bf16 v[88:91], a[236:239], v[108:111], v[88:91]
    ds_read_b128 a[48:51], v223 offset:4096
    v_mfma_f32_16x16x32_bf16 v[92:95], a[240:243], v[108:111], v[92:95]
    buffer_load_dwordx4 v[108:111], v211, s[28:31], s56 offen offset:2048 sc1
    s_waitcnt vmcnt(8)
    v_cmp_ne_u32 vcc, 1, v213
    s_nop 1
    s_cbranch_vccz SYNC3_DONE
    s_mov_b32 s3, 1048576
SYNC3_SPIN:
    buffer_load_dword v213, v212, s[28:31], s15 offen sc1
    s_waitcnt vmcnt(0)
    v_cmp_ne_u32 vcc, 1, v213
    s_sub_u32 s3, s3, 1
    s_cbranch_scc1 SYNC3_DONE
    s_cbranch_vccz SYNC3_DONE
    s_sleep 1
    s_branch SYNC3_SPIN
SYNC3_DONE:
    s_waitcnt vmcnt(12)
    v_mfma_f32_16x16x32_bf16 v[16:19], v[144:147], v[112:115], v[16:19]
    v_mfma_f32_16x16x32_bf16 v[20:23], v[148:151], v[112:115], v[20:23]
    ds_read_b128 a[0:3], v223 offset:5120
    v_mfma_f32_16x16x32_bf16 v[24:27], v[152:155], v[112:115], v[24:27]
    v_mfma_f32_16x16x32_bf16 v[28:31], v[156:159], v[112:115], v[28:31]
    ds_read_b128 a[4:7], v223 offset:6144
    v_mfma_f32_16x16x32_bf16 v[32:35], v[160:163], v[112:115], v[32:35]
    buffer_load_dwordx4 v[112:115], v224, s[28:31], 0 offen offset:0 sc1
    s_waitcnt vmcnt(12)
    v_mfma_f32_16x16x32_bf16 v[36:39], v[144:147], v[116:119], v[36:39]
    v_mfma_f32_16x16x32_bf16 v[40:43], v[148:151], v[116:119], v[40:43]
    v_mfma_f32_16x16x32_bf16 v[44:47], v[152:155], v[116:119], v[44:47]
    v_mfma_f32_16x16x32_bf16 v[48:51], v[156:159], v[116:119], v[48:51]
    ds_read_b128 a[8:11], v223 offset:7168
    v_mfma_f32_16x16x32_bf16 v[52:55], v[160:163], v[116:119], v[52:55]
    buffer_load_dwordx4 v[116:119], v225, s[28:31], 0 offen offset:0 sc1
    s_waitcnt vmcnt(12)
    v_mfma_f32_16x16x32_bf16 v[56:59], v[144:147], v[120:123], v[56:59]
    v_mfma_f32_16x16x32_bf16 v[60:63], v[148:151], v[120:123], v[60:63]
    v_mfma_f32_16x16x32_bf16 v[64:67], v[152:155], v[120:123], v[64:67]
    v_mfma_f32_16x16x32_bf16 v[68:71], v[156:159], v[120:123], v[68:71]
    ds_read_b128 a[12:15], v223 offset:8192
    v_mfma_f32_16x16x32_bf16 v[72:75], v[160:163], v[120:123], v[72:75]
    buffer_load_dwordx4 v[120:123], v226, s[28:31], 0 offen offset:0 sc1
    s_waitcnt vmcnt(12)
    v_mfma_f32_16x16x32_bf16 v[76:79], v[144:147], v[124:127], v[76:79]
    v_mfma_f32_16x16x32_bf16 v[80:83], v[148:151], v[124:127], v[80:83]
    v_mfma_f32_16x16x32_bf16 v[84:87], v[152:155], v[124:127], v[84:87]
    v_mfma_f32_16x16x32_bf16 v[88:91], v[156:159], v[124:127], v[88:91]
    ds_read_b128 a[16:19], v223 offset:9216
    v_mfma_f32_16x16x32_bf16 v[92:95], v[160:163], v[124:127], v[92:95]
    buffer_load_dwordx4 v[124:127], v227, s[28:31], 0 offen offset:0 sc1
    s_waitcnt vmcnt(11)
    v_mfma_f32_16x16x32_bf16 v[16:19], v[164:167], v[128:131], v[16:19]
    v_mfma_f32_16x16x32_bf16 v[20:23], v[168:171], v[128:131], v[20:23]
    ds_read_b128 a[64:67], v223 offset:10240
    v_mfma_f32_16x16x32_bf16 v[24:27], v[172:175], v[128:131], v[24:27]
    v_mfma_f32_16x16x32_bf16 v[28:31], v[176:179], v[128:131], v[28:31]
    ds_read_b128 a[68:71], v223 offset:11264
    v_mfma_f32_16x16x32_bf16 v[32:35], v[180:183], v[128:131], v[32:35]
    buffer_load_dwordx4 v[128:131], v224, s[28:31], 0 offen offset:2560 sc1
    s_waitcnt vmcnt(11)
    v_mfma_f32_16x16x32_bf16 v[36:39], v[164:167], v[132:135], v[36:39]
    v_mfma_f32_16x16x32_bf16 v[40:43], v[168:171], v[132:135], v[40:43]
    v_mfma_f32_16x16x32_bf16 v[44:47], v[172:175], v[132:135], v[44:47]
    v_mfma_f32_16x16x32_bf16 v[48:51], v[176:179], v[132:135], v[48:51]
    ds_read_b128 a[72:75], v223 offset:12288
    v_mfma_f32_16x16x32_bf16 v[52:55], v[180:183], v[132:135], v[52:55]
    buffer_load_dwordx4 v[132:135], v225, s[28:31], 0 offen offset:2560 sc1
    s_waitcnt vmcnt(11)
    v_mfma_f32_16x16x32_bf16 v[56:59], v[164:167], v[136:139], v[56:59]
    v_mfma_f32_16x16x32_bf16 v[60:63], v[168:171], v[136:139], v[60:63]
    v_mfma_f32_16x16x32_bf16 v[64:67], v[172:175], v[136:139], v[64:67]
    v_mfma_f32_16x16x32_bf16 v[68:71], v[176:179], v[136:139], v[68:71]
    ds_read_b128 a[76:79], v223 offset:13312
    v_mfma_f32_16x16x32_bf16 v[72:75], v[180:183], v[136:139], v[72:75]
    buffer_load_dwordx4 v[136:139], v226, s[28:31], 0 offen offset:2560 sc1
    s_waitcnt vmcnt(11)
    v_mfma_f32_16x16x32_bf16 v[76:79], v[164:167], v[140:143], v[76:79]
    v_mfma_f32_16x16x32_bf16 v[80:83], v[168:171], v[140:143], v[80:83]
    v_mfma_f32_16x16x32_bf16 v[84:87], v[172:175], v[140:143], v[84:87]
    v_mfma_f32_16x16x32_bf16 v[88:91], v[176:179], v[140:143], v[88:91]
    ds_read_b128 a[80:83], v223 offset:14336
    v_mfma_f32_16x16x32_bf16 v[92:95], v[180:183], v[140:143], v[92:95]
    buffer_load_dwordx4 v[140:143], v227, s[28:31], 0 offen offset:2560 sc1
    s_waitcnt vmcnt(11)
    v_mfma_f32_16x16x32_bf16 v[16:19], v[184:187], v[96:99], v[16:19]
    v_mfma_f32_16x16x32_bf16 v[20:23], v[188:191], v[96:99], v[20:23]
    ds_read_b128 a[84:87], v223 offset:15360
    v_mfma_f32_16x16x32_bf16 v[24:27], v[192:195], v[96:99], v[24:27]
    v_mfma_f32_16x16x32_bf16 v[28:31], v[196:199], v[96:99], v[28:31]
    ds_read_b128 a[88:91], v223 offset:16384
    v_mfma_f32_16x16x32_bf16 v[32:35], v[200:203], v[96:99], v[32:35]
    buffer_load_dwordx4 v[96:99], v224, s[28:31], s63 offen offset:0 sc1
    s_waitcnt vmcnt(11)
    v_mfma_f32_16x16x32_bf16 v[36:39], v[184:187], v[100:103], v[36:39]
    v_mfma_f32_16x16x32_bf16 v[40:43], v[188:191], v[100:103], v[40:43]
    v_mfma_f32_16x16x32_bf16 v[44:47], v[192:195], v[100:103], v[44:47]
    v_mfma_f32_16x16x32_bf16 v[48:51], v[196:199], v[100:103], v[48:51]
    ds_read_b128 a[92:95], v223 offset:17408
    v_mfma_f32_16x16x32_bf16 v[52:55], v[200:203], v[100:103], v[52:55]
    buffer_load_dwordx4 v[100:103], v225, s[28:31], s63 offen offset:0 sc1
    s_waitcnt vmcnt(11)
    v_mfma_f32_16x16x32_bf16 v[56:59], v[184:187], v[104:107], v[56:59]
    v_mfma_f32_16x16x32_bf16 v[60:63], v[188:191], v[104:107], v[60:63]
    v_mfma_f32_16x16x32_bf16 v[64:67], v[192:195], v[104:107], v[64:67]
    v_mfma_f32_16x16x32_bf16 v[68:71], v[196:199], v[104:107], v[68:71]
    ds_read_b128 a[96:99], v223 offset:18432
    v_mfma_f32_16x16x32_bf16 v[72:75], v[200:203], v[104:107], v[72:75]
    buffer_load_dwordx4 v[104:107], v226, s[28:31], s63 offen offset:0 sc1
    s_waitcnt vmcnt(11)
    v_mfma_f32_16x16x32_bf16 v[76:79], v[184:187], v[108:111], v[76:79]
    v_mfma_f32_16x16x32_bf16 v[80:83], v[188:191], v[108:111], v[80:83]
    v_mfma_f32_16x16x32_bf16 v[84:87], v[192:195], v[108:111], v[84:87]
    v_mfma_f32_16x16x32_bf16 v[88:91], v[196:199], v[108:111], v[88:91]
    ds_read_b128 a[100:103], v223 offset:19456
    v_mfma_f32_16x16x32_bf16 v[92:95], v[200:203], v[108:111], v[92:95]
    buffer_load_dwordx4 v[108:111], v227, s[28:31], s63 offen offset:0 sc1
    s_waitcnt lgkmcnt(5)
    s_waitcnt vmcnt(11)
    v_mfma_f32_16x16x32_bf16 v[16:19], a[32:35], v[112:115], v[16:19]
    v_mfma_f32_16x16x32_bf16 v[20:23], a[36:39], v[112:115], v[20:23]
    ds_read_b128 a[104:107], v223 offset:20480
    v_mfma_f32_16x16x32_bf16 v[24:27], a[40:43], v[112:115], v[24:27]
    v_mfma_f32_16x16x32_bf16 v[28:31], a[44:47], v[112:115], v[28:31]
    ds_read_b128 a[108:111], v223 offset:21504
    v_mfma_f32_16x16x32_bf16 v[32:35], a[48:51], v[112:115], v[32:35]
    buffer_load_dwordx4 v[112:115], v224, s[28:31], s63 offen offset:2560 sc1
    s_waitcnt vmcnt(11)
    v_mfma_f32_16x16x32_bf16 v[36:39], a[32:35], v[116:119], v[36:39]
    v_mfma_f32_16x16x32_bf16 v[40:43], a[36:39], v[116:119], v[40:43]
    v_mfma_f32_16x16x32_bf16 v[44:47], a[40:43], v[116:119], v[44:47]
    v_mfma_f32_16x16x32_bf16 v[48:51], a[44:47], v[116:119], v[48:51]
    ds_read_b128 a[112:115], v223 offset:22528
    v_mfma_f32_16x16x32_bf16 v[52:55], a[48:51], v[116:119], v[52:55]
    buffer_load_dwordx4 v[116:119], v225, s[28:31], s63 offen offset:2560 sc1
    s_waitcnt vmcnt(11)
    v_mfma_f32_16x16x32_bf16 v[56:59], a[32:35], v[120:123], v[56:59]
    v_mfma_f32_16x16x32_bf16 v[60:63], a[36:39], v[120:123], v[60:63]
    v_mfma_f32_16x16x32_bf16 v[64:67], a[40:43], v[120:123], v[64:67]
    v_mfma_f32_16x16x32_bf16 v[68:71], a[44:47], v[120:123], v[68:71]
    ds_read_b128 a[116:119], v223 offset:23552
    v_mfma_f32_16x16x32_bf16 v[72:75], a[48:51], v[120:123], v[72:75]
    buffer_load_dwordx4 v[120:123], v226, s[28:31], s63 offen offset:2560 sc1
    s_waitcnt vmcnt(11)
    v_mfma_f32_16x16x32_bf16 v[76:79], a[32:35], v[124:127], v[76:79]
    v_mfma_f32_16x16x32_bf16 v[80:83], a[36:39], v[124:127], v[80:83]
    v_mfma_f32_16x16x32_bf16 v[84:87], a[40:43], v[124:127], v[84:87]
    v_mfma_f32_16x16x32_bf16 v[88:91], a[44:47], v[124:127], v[88:91]
    ds_read_b128 a[120:123], v223 offset:24576
    v_mfma_f32_16x16x32_bf16 v[92:95], a[48:51], v[124:127], v[92:95]
    buffer_load_dwordx4 v[124:127], v227, s[28:31], s63 offen offset:2560 sc1
    s_waitcnt lgkmcnt(0)
    s_waitcnt vmcnt(11)
    v_mfma_f32_16x16x32_bf16 v[16:19], a[0:3], v[128:131], v[16:19]
    v_mfma_f32_16x16x32_bf16 v[20:23], a[4:7], v[128:131], v[20:23]
    v_mfma_f32_16x16x32_bf16 v[24:27], a[8:11], v[128:131], v[24:27]
    v_mfma_f32_16x16x32_bf16 v[28:31], a[12:15], v[128:131], v[28:31]
    v_mfma_f32_16x16x32_bf16 v[32:35], a[16:19], v[128:131], v[32:35]
    buffer_load_dwordx2 v[128:129], v228, s[28:31], 0 offen offset:1024 sc1
    buffer_load_dwordx2 v[130:131], v228, s[28:31], 0 offen offset:2304 sc1
    s_waitcnt vmcnt(12)
    v_mfma_f32_16x16x32_bf16 v[36:39], a[0:3], v[132:135], v[36:39]
    v_mfma_f32_16x16x32_bf16 v[40:43], a[4:7], v[132:135], v[40:43]
    v_mfma_f32_16x16x32_bf16 v[44:47], a[8:11], v[132:135], v[44:47]
    v_mfma_f32_16x16x32_bf16 v[48:51], a[12:15], v[132:135], v[48:51]
    v_mfma_f32_16x16x32_bf16 v[52:55], a[16:19], v[132:135], v[52:55]
    buffer_load_dwordx2 v[132:133], v229, s[28:31], 0 offen offset:1024 sc1
    buffer_load_dwordx2 v[134:135], v229, s[28:31], 0 offen offset:2304 sc1
    s_waitcnt vmcnt(13)
    v_mfma_f32_16x16x32_bf16 v[56:59], a[0:3], v[136:139], v[56:59]
    v_mfma_f32_16x16x32_bf16 v[60:63], a[4:7], v[136:139], v[60:63]
    v_mfma_f32_16x16x32_bf16 v[64:67], a[8:11], v[136:139], v[64:67]
    v_mfma_f32_16x16x32_bf16 v[68:71], a[12:15], v[136:139], v[68:71]
    v_mfma_f32_16x16x32_bf16 v[72:75], a[16:19], v[136:139], v[72:75]
    buffer_load_dwordx2 v[136:137], v230, s[28:31], 0 offen offset:1024 sc1
    buffer_load_dwordx2 v[138:139], v230, s[28:31], 0 offen offset:2304 sc1
    s_waitcnt vmcnt(14)
    v_mfma_f32_16x16x32_bf16 v[76:79], a[0:3], v[140:143], v[76:79]
    v_mfma_f32_16x16x32_bf16 v[80:83], a[4:7], v[140:143], v[80:83]
    v_mfma_f32_16x16x32_bf16 v[84:87], a[8:11], v[140:143], v[84:87]
    v_mfma_f32_16x16x32_bf16 v[88:91], a[12:15], v[140:143], v[88:91]
    v_mfma_f32_16x16x32_bf16 v[92:95], a[16:19], v[140:143], v[92:95]
    buffer_load_dwordx2 v[140:141], v231, s[28:31], 0 offen offset:1024 sc1
    buffer_load_dwordx2 v[142:143], v231, s[28:31], 0 offen offset:2304 sc1
    s_waitcnt lgkmcnt(0)
    s_waitcnt vmcnt(15)
    v_mfma_f32_16x16x32_bf16 v[16:19], a[64:67], v[96:99], v[16:19]
    v_mfma_f32_16x16x32_bf16 v[20:23], a[68:71], v[96:99], v[20:23]
    v_mfma_f32_16x16x32_bf16 v[24:27], a[72:75], v[96:99], v[24:27]
    v_mfma_f32_16x16x32_bf16 v[28:31], a[76:79], v[96:99], v[28:31]
    v_mfma_f32_16x16x32_bf16 v[32:35], a[80:83], v[96:99], v[32:35]
    s_waitcnt vmcnt(14)
    v_mfma_f32_16x16x32_bf16 v[36:39], a[64:67], v[100:103], v[36:39]
    v_mfma_f32_16x16x32_bf16 v[40:43], a[68:71], v[100:103], v[40:43]
    v_mfma_f32_16x16x32_bf16 v[44:47], a[72:75], v[100:103], v[44:47]
    v_mfma_f32_16x16x32_bf16 v[48:51], a[76:79], v[100:103], v[48:51]
    v_mfma_f32_16x16x32_bf16 v[52:55], a[80:83], v[100:103], v[52:55]
    s_waitcnt vmcnt(13)
    v_mfma_f32_16x16x32_bf16 v[56:59], a[64:67], v[104:107], v[56:59]
    v_mfma_f32_16x16x32_bf16 v[60:63], a[68:71], v[104:107], v[60:63]
    v_mfma_f32_16x16x32_bf16 v[64:67], a[72:75], v[104:107], v[64:67]
    v_mfma_f32_16x16x32_bf16 v[68:71], a[76:79], v[104:107], v[68:71]
    v_mfma_f32_16x16x32_bf16 v[72:75], a[80:83], v[104:107], v[72:75]
    s_waitcnt vmcnt(12)
    v_mfma_f32_16x16x32_bf16 v[76:79], a[64:67], v[108:111], v[76:79]
    v_mfma_f32_16x16x32_bf16 v[80:83], a[68:71], v[108:111], v[80:83]
    v_mfma_f32_16x16x32_bf16 v[84:87], a[72:75], v[108:111], v[84:87]
    v_mfma_f32_16x16x32_bf16 v[88:91], a[76:79], v[108:111], v[88:91]
    v_mfma_f32_16x16x32_bf16 v[92:95], a[80:83], v[108:111], v[92:95]
    s_waitcnt vmcnt(11)
    v_mfma_f32_16x16x32_bf16 v[16:19], a[84:87], v[112:115], v[16:19]
    v_mfma_f32_16x16x32_bf16 v[20:23], a[88:91], v[112:115], v[20:23]
    v_mfma_f32_16x16x32_bf16 v[24:27], a[92:95], v[112:115], v[24:27]
    v_mfma_f32_16x16x32_bf16 v[28:31], a[96:99], v[112:115], v[28:31]
    v_mfma_f32_16x16x32_bf16 v[32:35], a[100:103], v[112:115], v[32:35]
    s_waitcnt vmcnt(6)
    v_mfma_f32_16x16x32_bf16 v[16:19], a[104:107], v[128:131], v[16:19]
    v_mfma_f32_16x16x32_bf16 v[20:23], a[108:111], v[128:131], v[20:23]
    v_mfma_f32_16x16x32_bf16 v[24:27], a[112:115], v[128:131], v[24:27]
    v_mfma_f32_16x16x32_bf16 v[28:31], a[116:119], v[128:131], v[28:31]
    v_mfma_f32_16x16x32_bf16 v[32:35], a[120:123], v[128:131], v[32:35]
    s_waitcnt vmcnt(10)
    v_mfma_f32_16x16x32_bf16 v[36:39], a[84:87], v[116:119], v[36:39]
    v_mfma_f32_16x16x32_bf16 v[40:43], a[88:91], v[116:119], v[40:43]
    v_mfma_f32_16x16x32_bf16 v[44:47], a[92:95], v[116:119], v[44:47]
    v_mfma_f32_16x16x32_bf16 v[48:51], a[96:99], v[116:119], v[48:51]
    v_mfma_f32_16x16x32_bf16 v[52:55], a[100:103], v[116:119], v[52:55]
    ds_write_b128 v222, v[16:19] offset:0
    s_waitcnt vmcnt(4)
    v_mfma_f32_16x16x32_bf16 v[36:39], a[104:107], v[132:135], v[36:39]
    ds_write_b128 v222, v[20:23] offset:64
    v_mfma_f32_16x16x32_bf16 v[40:43], a[108:111], v[132:135], v[40:43]
    ds_write_b128 v222, v[24:27] offset:128
    v_mfma_f32_16x16x32_bf16 v[44:47], a[112:115], v[132:135], v[44:47]
    ds_write_b128 v222, v[28:31] offset:192
    v_mfma_f32_16x16x32_bf16 v[48:51], a[116:119], v[132:135], v[48:51]
    ds_write_b128 v222, v[32:35] offset:256
    v_mfma_f32_16x16x32_bf16 v[52:55], a[120:123], v[132:135], v[52:55]
    s_waitcnt vmcnt(9)
    v_mfma_f32_16x16x32_bf16 v[56:59], a[84:87], v[120:123], v[56:59]
    v_mfma_f32_16x16x32_bf16 v[60:63], a[88:91], v[120:123], v[60:63]
    v_mfma_f32_16x16x32_bf16 v[64:67], a[92:95], v[120:123], v[64:67]
    v_mfma_f32_16x16x32_bf16 v[68:71], a[96:99], v[120:123], v[68:71]
    v_mfma_f32_16x16x32_bf16 v[72:75], a[100:103], v[120:123], v[72:75]
    ds_write_b128 v222, v[36:39] offset:5376
    s_waitcnt vmcnt(2)
    v_mfma_f32_16x16x32_bf16 v[56:59], a[104:107], v[136:139], v[56:59]
    ds_write_b128 v222, v[40:43] offset:5440
    v_mfma_f32_16x16x32_bf16 v[60:63], a[108:111], v[136:139], v[60:63]
    ds_write_b128 v222, v[44:47] offset:5504
    v_mfma_f32_16x16x32_bf16 v[64:67], a[112:115], v[136:139], v[64:67]
    ds_write_b128 v222, v[48:51] offset:5568
    v_mfma_f32_16x16x32_bf16 v[68:71], a[116:119], v[136:139], v[68:71]
    ds_write_b128 v222, v[52:55] offset:5632
    v_mfma_f32_16x16x32_bf16 v[72:75], a[120:123], v[136:139], v[72:75]
    s_waitcnt vmcnt(8)
    v_mfma_f32_16x16x32_bf16 v[76:79], a[84:87], v[124:127], v[76:79]
    v_mfma_f32_16x16x32_bf16 v[80:83], a[88:91], v[124:127], v[80:83]
    v_mfma_f32_16x16x32_bf16 v[84:87], a[92:95], v[124:127], v[84:87]
    v_mfma_f32_16x16x32_bf16 v[88:91], a[96:99], v[124:127], v[88:91]
    v_mfma_f32_16x16x32_bf16 v[92:95], a[100:103], v[124:127], v[92:95]
    ds_write_b128 v222, v[56:59] offset:10752
    s_waitcnt vmcnt(0)
    v_mfma_f32_16x16x32_bf16 v[76:79], a[104:107], v[140:143], v[76:79]
    ds_write_b128 v222, v[60:63] offset:10816
    v_mfma_f32_16x16x32_bf16 v[80:83], a[108:111], v[140:143], v[80:83]
    ds_write_b128 v222, v[64:67] offset:10880
    v_mfma_f32_16x16x32_bf16 v[84:87], a[112:115], v[140:143], v[84:87]
    ds_write_b128 v222, v[68:71] offset:10944
    v_mfma_f32_16x16x32_bf16 v[88:91], a[116:119], v[140:143], v[88:91]
    ds_write_b128 v222, v[72:75] offset:11008
    v_mfma_f32_16x16x32_bf16 v[92:95], a[120:123], v[140:143], v[92:95]
    s_nop 4
    ds_write_b128 v222, v[76:79] offset:16128
    ds_write_b128 v222, v[80:83] offset:16192
    ds_write_b128 v222, v[84:87] offset:16256
    ds_write_b128 v222, v[88:91] offset:16320
    ds_write_b128 v222, v[92:95] offset:16384
    s_waitcnt lgkmcnt(0)
    s_barrier
    ds_read_b128 v[16:19], v237 offset:0
    ds_read_b128 v[20:23], v237 offset:30720
    ds_read_b128 v[24:27], v215 offset:0
    ds_read_b128 v[28:31], v215 offset:30720
    ds_read_b128 v[32:35], v238 offset:0
    ds_read_b128 v[36:39], v238 offset:30720
    ds_read_b128 v[40:43], v216 offset:0
    ds_read_b128 v[44:47], v216 offset:30720
    ds_read_b128 v[48:51], v239 offset:0
    ds_read_b128 v[52:55], v239 offset:30720
    ds_read_b128 v[56:59], v217 offset:0
    ds_read_b128 v[60:63], v217 offset:30720
    ds_read_b128 v[64:67], v240 offset:0
    ds_read_b128 v[68:71], v240 offset:30720
    ds_read_b128 v[72:75], v218 offset:0
    ds_read_b128 v[76:79], v218 offset:30720
    ds_read_b128 v[80:83], v241 offset:0
    ds_read_b128 v[84:87], v241 offset:30720
    ds_read_b128 v[88:91], v219 offset:0
    ds_read_b128 v[92:95], v219 offset:30720
    s_waitcnt lgkmcnt(15)
    v_pk_add_f32 v[16:17], v[16:17], v[20:21]
    v_pk_add_f32 v[24:25], v[24:25], v[28:29]
    v_pk_add_f32 v[18:19], v[18:19], v[22:23]
    v_pk_add_f32 v[26:27], v[26:27], v[30:31]
    v_pk_add_f32 v[16:17], v[16:17], v[24:25]
    v_pk_add_f32 v[18:19], v[18:19], v[26:27]
    v_cvt_pk_bf16_f32 v20, v16, v17
    v_cvt_pk_bf16_f32 v21, v18, v19
    buffer_store_dwordx2 v[20:21], v232, s[32:35], s42 offen
    s_waitcnt lgkmcnt(12)
    v_pk_add_f32 v[32:33], v[32:33], v[36:37]
    v_pk_add_f32 v[40:41], v[40:41], v[44:45]
    v_pk_add_f32 v[34:35], v[34:35], v[38:39]
    v_pk_add_f32 v[42:43], v[42:43], v[46:47]
    v_pk_add_f32 v[32:33], v[32:33], v[40:41]
    v_pk_add_f32 v[34:35], v[34:35], v[42:43]
    v_cvt_pk_bf16_f32 v36, v32, v33
    v_cvt_pk_bf16_f32 v37, v34, v35
    buffer_store_dwordx2 v[36:37], v233, s[32:35], s42 offen
    s_waitcnt lgkmcnt(8)
    v_pk_add_f32 v[48:49], v[48:49], v[52:53]
    v_pk_add_f32 v[56:57], v[56:57], v[60:61]
    v_pk_add_f32 v[50:51], v[50:51], v[54:55]
    v_pk_add_f32 v[58:59], v[58:59], v[62:63]
    v_pk_add_f32 v[48:49], v[48:49], v[56:57]
    v_pk_add_f32 v[50:51], v[50:51], v[58:59]
    v_cvt_pk_bf16_f32 v52, v48, v49
    v_cvt_pk_bf16_f32 v53, v50, v51
    buffer_store_dwordx2 v[52:53], v234, s[32:35], s42 offen
    s_waitcnt lgkmcnt(4)
    v_pk_add_f32 v[64:65], v[64:65], v[68:69]
    v_pk_add_f32 v[72:73], v[72:73], v[76:77]
    v_pk_add_f32 v[66:67], v[66:67], v[70:71]
    v_pk_add_f32 v[74:75], v[74:75], v[78:79]
    v_pk_add_f32 v[64:65], v[64:65], v[72:73]
    v_pk_add_f32 v[66:67], v[66:67], v[74:75]
    v_cvt_pk_bf16_f32 v68, v64, v65
    v_cvt_pk_bf16_f32 v69, v66, v67
    buffer_store_dwordx2 v[68:69], v235, s[32:35], s42 offen
    s_waitcnt lgkmcnt(0)
    v_pk_add_f32 v[80:81], v[80:81], v[84:85]
    v_pk_add_f32 v[88:89], v[88:89], v[92:93]
    v_pk_add_f32 v[82:83], v[82:83], v[86:87]
    v_pk_add_f32 v[90:91], v[90:91], v[94:95]
    v_pk_add_f32 v[80:81], v[80:81], v[88:89]
    v_pk_add_f32 v[82:83], v[82:83], v[90:91]
    v_cvt_pk_bf16_f32 v84, v80, v81
    v_cvt_pk_bf16_f32 v85, v82, v83
    buffer_store_dwordx2 v[84:85], v236, s[32:35], s42 offen
MK_END:
    s_endpgm
P2_SLOW:
    s_mov_b32 s5, 1
    s_waitcnt vmcnt(0)
    s_mov_b32 s46, 2629632
    buffer_load_dwordx4 v[16:19], v3, s[28:31], s20 offen sc1
    buffer_load_dwordx4 v[20:23], v3, s[28:31], s20 offen offset:1280 sc1
    buffer_load_dwordx2 v[24:25], v7, s[28:31], s20 offen offset:1024 sc1
    buffer_load_dwordx2 v[26:27], v7, s[28:31], s20 offen offset:2304 sc1
    v_mov_b32 v28, 0xff800000
    v_mov_b32 v29, 0xff800000
    v_mul_u32_u24 v30, 1280, v5
    v_cmp_eq_u32 vcc, 0, v2
    s_nop 0
    s_waitcnt vmcnt(0)
    v_cndmask_b32 v24, 0, v24, vcc
    v_cndmask_b32 v25, 0, v25, vcc
    v_cndmask_b32 v26, 0, v26, vcc
    v_cndmask_b32 v27, 0, v27, vcc
    s_mov_b32 s4, 0
P2_SLOW1:
    s_mul_i32 s12, s4, 1280
    s_add_u32 s12, s12, s26
    s_add_u32 s12, s12, 0x280000
    buffer_load_dwordx4 v[128:131], v3, s[28:31], s12 offen sc1
    buffer_load_dwordx2 v[132:133], v7, s[28:31], s12 offen offset:1024 sc1
    s_waitcnt vmcnt(0)
    v_mfma_f32_32x32x16_bf16 v[96:111], v[128:131], v[16:19], 0
    v_mfma_f32_32x32x8_bf16 v[96:111], v[132:133], v[24:25], v[96:111]
    v_mfma_f32_32x32x16_bf16 v[112:127], v[128:131], v[20:23], 0
    v_mfma_f32_32x32x8_bf16 v[112:127], v[132:133], v[26:27], v[112:127]
    s_nop 15
    v_max3_f32 v28, v96, v97, v28
    v_max3_f32 v28, v98, v99, v28
    v_max3_f32 v28, v100, v101, v28
    v_max3_f32 v28, v102, v103, v28
    v_max3_f32 v28, v104, v105, v28
    v_max3_f32 v28, v106, v107, v28
    v_max3_f32 v28, v108, v109, v28
    v_max3_f32 v28, v110, v111, v28
    v_max3_f32 v29, v112, v113, v29
    v_max3_f32 v29, v114, v115, v29
    v_max3_f32 v29, v116, v117, v29
    v_max3_f32 v29, v118, v119, v29
    v_max3_f32 v29, v120, v121, v29
    v_max3_f32 v29, v122, v123, v29
    v_max3_f32 v29, v124, v125, v29
    v_max3_f32 v29, v126, v127, v29
    s_add_u32 s4, s4, 1
    s_cmp_lt_u32 s4, 64
    s_cbranch_scc1 P2_SLOW1
    v_mov_b32 v32, v28
    v_mov_b32 v33, v28
    v_mov_b32 v34, v29
    v_mov_b32 v35, v29
    s_nop 1
    v_permlane32_swap_b32 v32, v33
    v_permlane32_swap_b32 v34, v35
    s_nop 1
    v_max_f32 v28, v32, v33
    v_max_f32 v29, v34, v35
    s_mov_b32 s4, 0
    v_mov_b32 v40, 0
    v_mov_b32 v41, 0
    v_mov_b32 v42, 0
    v_mov_b32 v43, 0
    v_mov_b32 v44, 0
    v_mov_b32 v45, 0
    v_mov_b32 v46, 0
    v_mov_b32 v47, 0
    v_mov_b32 v48, 0
    v_mov_b32 v49, 0
    v_mov_b32 v50, 0
    v_mov_b32 v51, 0
    v_mov_b32 v52, 0
    v_mov_b32 v53, 0
    v_mov_b32 v54, 0
    v_mov_b32 v55, 0
    v_mov_b32 v56, 0
    v_mov_b32 v57, 0
    v_mov_b32 v58, 0
    v_mov_b32 v59, 0
    v_mov_b32 v60, 0
    v_mov_b32 v61, 0
    v_mov_b32 v62, 0
    v_mov_b32 v63, 0
    v_mov_b32 v64, 0
    v_mov_b32 v65, 0
    v_mov_b32 v66, 0
    v_mov_b32 v67, 0
    v_mov_b32 v68, 0
    v_mov_b32 v69, 0
    v_mov_b32 v70, 0
    v_mov_b32 v71, 0
P2_SLOW2:
    s_mul_i32 s12, s4, 1280
    s_add_u32 s12, s12, s26
    s_add_u32 s12, s12, 0x280000
    buffer_load_dwordx4 v[128:131], v3, s[28:31], s12 offen sc1
    buffer_load_dwordx2 v[132:133], v7, s[28:31], s12 offen offset:1024 sc1
    buffer_load_dwordx4 v[136:139], v9, s[44:47], 0 offen sc1
    buffer_load_dwordx4 v[140:143], v9, s[44:47], 0 offen offset:640 sc1
    v_add_u32 v9, v9, v30
    s_waitcnt vmcnt(0)
    v_mfma_f32_32x32x16_bf16 v[96:111], v[128:131], v[16:19], 0
    v_mfma_f32_32x32x8_bf16 v[96:111], v[132:133], v[24:25], v[96:111]
    v_mfma_f32_32x32x16_bf16 v[112:127], v[128:131], v[20:23], 0
    v_mfma_f32_32x32x8_bf16 v[112:127], v[132:133], v[26:27], v[112:127]
    s_nop 15
    v_sub_f32 v96, v96, v28
    v_sub_f32 v97, v97, v28
    v_sub_f32 v98, v98, v28
    v_sub_f32 v99, v99, v28
    v_sub_f32 v100, v100, v28
    v_sub_f32 v101, v101, v28
    v_sub_f32 v102, v102, v28
    v_sub_f32 v103, v103, v28
    v_sub_f32 v104, v104, v28
    v_sub_f32 v105, v105, v28
    v_sub_f32 v106, v106, v28
    v_sub_f32 v107, v107, v28
    v_sub_f32 v108, v108, v28
    v_sub_f32 v109, v109, v28
    v_sub_f32 v110, v110, v28
    v_sub_f32 v111, v111, v28
    v_exp_f32 v96, v96
    v_exp_f32 v97, v97
    v_exp_f32 v98, v98
    v_exp_f32 v99, v99
    v_exp_f32 v100, v100
    v_exp_f32 v101, v101
    v_exp_f32 v102, v102
    v_exp_f32 v103, v103
    v_exp_f32 v104, v104
    v_exp_f32 v105, v105
    v_exp_f32 v106, v106
    v_exp_f32 v107, v107
    v_exp_f32 v108, v108
    v_exp_f32 v109, v109
    v_exp_f32 v110, v110
    v_exp_f32 v111, v111
    s_nop 0
    v_cvt_pk_bf16_f32 v96, v96, v97
    v_cvt_pk_bf16_f32 v97, v98, v99
    v_cvt_pk_bf16_f32 v98, v100, v101
    v_cvt_pk_bf16_f32 v99, v102, v103
    v_cvt_pk_bf16_f32 v100, v104, v105
    v_cvt_pk_bf16_f32 v101, v106, v107
    v_cvt_pk_bf16_f32 v102, v108, v109
    v_cvt_pk_bf16_f32 v103, v110, v111
    s_nop 1
    v_mfma_f32_32x32x16_bf16 v[40:55], v[136:139], v[96:99], v[40:55]
    v_mfma_f32_32x32x16_bf16 v[40:55], v[140:143], v[100:103], v[40:55]
    v_sub_f32 v112, v112, v29
    v_sub_f32 v113, v113, v29
    v_sub_f32 v114, v114, v29
    v_sub_f32 v115, v115, v29
    v_sub_f32 v116, v116, v29
    v_sub_f32 v117, v117, v29
    v_sub_f32 v118, v118, v29
    v_sub_f32 v119, v119, v29
    v_sub_f32 v120, v120, v29
    v_sub_f32 v121, v121, v29
    v_sub_f32 v122, v122, v29
    v_sub_f32 v123, v123, v29
    v_sub_f32 v124, v124, v29
    v_sub_f32 v125, v125, v29
    v_sub_f32 v126, v126, v29
    v_sub_f32 v127, v127, v29
    v_exp_f32 v112, v112
    v_exp_f32 v113, v113
    v_exp_f32 v114, v114
    v_exp_f32 v115, v115
    v_exp_f32 v116, v116
    v_exp_f32 v117, v117
    v_exp_f32 v118, v118
    v_exp_f32 v119, v119
    v_exp_f32 v120, v120
    v_exp_f32 v121, v121
    v_exp_f32 v122, v122
    v_exp_f32 v123, v123
    v_exp_f32 v124, v124
    v_exp_f32 v125, v125
    v_exp_f32 v126, v126
    v_exp_f32 v127, v127
    s_nop 0
    v_cvt_pk_bf16_f32 v112, v112, v113
    v_cvt_pk_bf16_f32 v113, v114, v115
    v_cvt_pk_bf16_f32 v114, v116, v117
    v_cvt_pk_bf16_f32 v115, v118, v119
    v_cvt_pk_bf16_f32 v116, v120, v121
    v_cvt_pk_bf16_f32 v117, v122, v123
    v_cvt_pk_bf16_f32 v118, v124, v125
    v_cvt_pk_bf16_f32 v119, v126, v127
    s_nop 1
    v_mfma_f32_32x32x16_bf16 v[56:71], v[136:139], v[112:115], v[56:71]
    v_mfma_f32_32x32x16_bf16 v[56:71], v[140:143], v[116:119], v[56:71]
    s_add_u32 s4, s4, 1
    s_cmp_lt_u32 s4, 64
    s_cbranch_scc1 P2_SLOW2
    s_nop 15
    buffer_load_dwordx4 v[112:115], v208, s[28:31], s16 offen offset:0 sc1
    buffer_load_dwordx4 v[116:119], v209, s[28:31], s16 offen offset:0 sc1
    buffer_load_dwordx4 v[120:123], v210, s[28:31], s16 offen offset:0 sc1
    buffer_load_dwordx4 v[124:127], v211, s[28:31], s16 offen offset:0 sc1
    buffer_load_dwordx4 v[128:131], v208, s[28:31], s16 offen offset:2048 sc1
    buffer_load_dwordx4 v[132:135], v209, s[28:31], s16 offen offset:2048 sc1
    buffer_load_dwordx4 v[136:139], v210, s[28:31], s16 offen offset:2048 sc1
    buffer_load_dwordx4 v[140:143], v211, s[28:31], s16 offen offset:2048 sc1
    buffer_load_dwordx4 v[96:99], v208, s[28:31], s22 offen offset:0 sc1
    buffer_load_dwordx4 v[100:103], v209, s[28:31], s22 offen offset:0 sc1
    buffer_load_dwordx4 v[104:107], v210, s[28:31], s22 offen offset:0 sc1
    buffer_load_dwordx4 v[108:111], v211, s[28:31], s22 offen offset:0 sc1
    s_branch P2_FIN
.section .rodata,"a"
.p2align 6
.amdhsa_kernel gated_mix__softmax_full_mha__glu_gated_geglu__prompt_kernel
  .amdhsa_next_free_vgpr 496
  .amdhsa_next_free_sgpr 102
  .amdhsa_accum_offset 252
  .amdhsa_group_segment_fixed_size 0
  .amdhsa_kernarg_size 88
  .amdhsa_user_sgpr_count 2
  .amdhsa_user_sgpr_kernarg_segment_ptr 1
  .amdhsa_system_sgpr_workgroup_id_x 1
.end_amdhsa_kernel
```
